```python
import torch

def _softmax(x, axis=-1):
    return torch.softmax(x, dim=axis)
def _gelu(x):
    return torch.nn.functional.gelu(x, approximate="tanh")
def _silu(x):
    return torch.nn.functional.silu(x)
def _sigmoid(x):
    return torch.sigmoid(x)
def _layernorm(x, axis=-1, eps=1e-5):
    m = x.mean(dim=axis, keepdim=True)
    v = x.var(dim=axis, keepdim=True, unbiased=False)
    return (x - m) / torch.sqrt(v + eps)
def _scatter_add(tgt, idx, src, axis=0):
    return tgt.clone().index_add_(axis, idx, src)
def _segment_sum(src, seg, n):
    out = torch.zeros((n,) + src.shape[1:], dtype=src.dtype)
    return out.index_add_(0, seg, src)
def _pad(x, pw):
    flat = tuple(v for pair in reversed(pw) for v in pair)
    return torch.nn.functional.pad(x, flat)

kernel_name = 'standalone__mha_softmax__near_ridge'

def setup_inputs():

    _w = (lambda a: (lambda t: t.to(torch.bfloat16) if t.is_floating_point() else t)(torch.as_tensor(a)))
    B, H, Sq, Sk, D = 16, 32, 256, 256, 128
    return {
        "q": _w((lambda *s: torch.randn(*s, dtype=torch.bfloat16) * 0.8)(B, H, Sq, D)),
        "k": _w((lambda *s: torch.randn(*s, dtype=torch.bfloat16) * 0.8)(B, H, Sk, D)),
        "v": _w((lambda *s: torch.randn(*s, dtype=torch.bfloat16) * 0.05)(B, H, Sk, D)),
    }

def reference(q, k, v):
    scale = q.shape[-1] ** -0.5
    scores = torch.einsum("bhqd,bhkd->bhqk", q, k) * scale
    p = _softmax(scores, axis=-1)
    return torch.einsum("bhqk,bhkd->bhqd", p, v)
```

```asm
; @launch grid=(256,1,1) block=(512,1,1) lds=163840
.amdgcn_target "amdgcn-amd-amdhsa--gfx950"
.text
.globl standalone__mha_softmax__near_ridge_kernel
.p2align 8
.type standalone__mha_softmax__near_ridge_kernel,@function
standalone__mha_softmax__near_ridge_kernel:
    s_cmp_ge_u32 s2, 256
    s_cbranch_scc1 L_end
    s_load_dwordx8 s[4:11], s[0:1], 0
    s_getpc_b64 s[50:51]
L_pc:
    v_lshlrev_b32 v160, 6, v0
    v_min_u32 v160, L_end-L_pc, v160
    v_mov_b32 v161, s51
    v_add_co_u32 v160, vcc, s50, v160
    v_lshrrev_b32 v5, 6, v0
    v_and_b32 v224, 63, v0
    v_addc_co_u32 v161, vcc, 0, v161, vcc
    global_load_dword v162, v[160:161], off
    v_readfirstlane_b32 s3, v5
    v_and_b32 v225, 15, v224
    v_lshrrev_b32 v226, 4, v224
    v_and_b32 v227, 7, v224
    v_lshrrev_b32 v228, 3, v224
    v_xor_b32 v227, v227, v228
    v_lshlrev_b32 v1, 13, v5
    v_lshl_add_u32 v1, v227, 4, v1
    v_lshl_add_u32 v1, v228, 8, v1
    s_lshl_b32 s28, s2, 17
    s_lshl_b32 s30, s3, 10
    s_lshl_b32 s35, s3, 12
    v_lshl_add_u32 v228, v5, 2, v226
    v_lshlrev_b32 v227, 8, v228
    v_and_b32 v2, 15, v228
    v_xor_b32 v2, v2, v225
    v_lshl_add_u32 v2, v2, 4, v227
    s_mov_b32 s18, 33554432
    s_mov_b32 s19, 0x20000
    s_mov_b32 s14, 33554432
    s_mov_b32 s15, 0x20000
    s_waitcnt lgkmcnt(0)
    s_mov_b64 s[16:17], s[6:7]
    s_mov_b64 s[12:13], s[4:5]
    s_mov_b64 s[20:21], s[8:9]
    s_mov_b64 s[24:25], s[10:11]
    s_add_u32 m0, s30, 0
    s_add_u32 s31, s28, 0
    buffer_load_dwordx4 v2, s[16:19], s31 offen offset:0 nt lds
    s_add_u32 m0, s30, 8192
    s_add_u32 s31, s28, 8192
    buffer_load_dwordx4 v2, s[16:19], s31 offen offset:0 nt lds
    s_add_u32 m0, s35, 131072
    s_add_u32 s31, s28, 0
    buffer_load_dwordx4 v1, s[12:15], s31 offen offset:0 nt lds
    s_add_u32 m0, s35, 132096
    s_add_u32 s31, s28, 2048
    buffer_load_dwordx4 v1, s[12:15], s31 offen offset:0 nt lds
    s_add_u32 m0, s35, 133120
    s_add_u32 s31, s28, 4096
    buffer_load_dwordx4 v1, s[12:15], s31 offen offset:0 nt lds
    s_add_u32 m0, s35, 134144
    s_add_u32 s31, s28, 6144
    buffer_load_dwordx4 v1, s[12:15], s31 offen offset:0 nt lds
    s_add_u32 s29, s28, 0x10000
    s_add_u32 s32, s28, 4096
    s_add_u32 s33, s29, 4096
    s_mov_b32 s22, 33554432
    s_mov_b32 s23, 0x20000
    s_mov_b32 s26, 33554432
    s_mov_b32 s27, 0x20000
    v_and_b32 v228, 7, v228
    v_lshlrev_b32 v228, 1, v228
    v_xor_b32 v228, v228, v225
    v_lshl_add_u32 v3, v228, 4, v227
    s_mov_b32 s40, 0x3e0293ee
    s_mov_b32 s41, 0xbe0293ee
    s_mov_b32 s44, 0x5d800000
    s_mov_b32 s34, 0
    v_xor_b32 v228, v225, v226
    v_lshlrev_b32 v20, 8, v225
    v_lshl_add_u32 v20, v228, 4, v20
    v_xor_b32 v21, 64, v20
    v_xor_b32 v22, 128, v20
    v_xor_b32 v23, 192, v20
    v_and_b32 v228, 7, v225
    v_xor_b32 v228, v228, v226
    v_lshlrev_b32 v227, 7, v225
    v_lshl_add_u32 v227, v5, 12, v227
    v_lshl_add_u32 v4, v228, 4, v227
    v_add_u32 v4, 98304, v4
    v_lshrrev_b32 v228, 1, v226
    v_and_b32 v6, 7, v225
    v_xor_b32 v228, v228, v6
    v_lshl_add_u32 v6, v228, 4, v227
    v_and_b32 v228, 1, v226
    v_lshl_add_u32 v6, v228, 3, v6
    v_add_u32 v6, 131072, v6
    v_lshrrev_b32 v252, 3, v224
    v_and_b32 v228, 7, v224
    v_xor_b32 v7, v228, v252
    v_lshlrev_b32 v7, 4, v7
    v_lshl_add_u32 v7, v252, 7, v7
    v_lshl_add_u32 v7, v5, 12, v7
    v_add_u32 v7, 131072, v7
    v_lshlrev_b32 v252, 8, v252
    v_lshl_add_u32 v252, v228, 4, v252
    v_lshl_add_u32 v252, v5, 13, v252
    v_lshrrev_b32 v227, 2, v224
    v_and_b32 v228, 7, v227
    v_lshlrev_b32 v228, 1, v228
    v_bfe_u32 v24, v224, 1, 1
    v_xor_b32 v228, v228, v24
    v_lshlrev_b32 v24, 8, v227
    v_lshl_add_u32 v24, v228, 4, v24
    v_and_b32 v228, 1, v224
    v_lshl_add_u32 v24, v228, 3, v24
    v_add_u32 v24, 0x10000, v24
    v_xor_b32 v25, 32, v24
    v_xor_b32 v26, 64, v24
    v_xor_b32 v27, 96, v24
    v_xor_b32 v28, 128, v24
    v_xor_b32 v29, 160, v24
    v_xor_b32 v30, 192, v24
    v_xor_b32 v31, 224, v24
    v_and_b32 v228, 3, v224
    v_min_u32 v228, 1, v228
    v_add_u32 v228, -1, v228
    v_and_b32 v8, 0x3f803f80, v228
    v_and_b32 v9, 0x3f803f80, v228
    v_and_b32 v10, 0x3f803f80, v228
    v_and_b32 v11, 0x3f803f80, v228
    s_waitcnt vmcnt(4)
    s_add_u32 m0, s35, 98304
    s_add_u32 s31, s28, 128
    buffer_load_dwordx4 v1, s[12:15], s31 offen offset:0 nt lds
    s_add_u32 m0, s35, 99328
    s_add_u32 s31, s28, 2176
    buffer_load_dwordx4 v1, s[12:15], s31 offen offset:0 nt lds
    s_add_u32 m0, s35, 100352
    s_add_u32 s31, s28, 4224
    buffer_load_dwordx4 v1, s[12:15], s31 offen offset:0 nt lds
    s_add_u32 m0, s35, 101376
    s_add_u32 s31, s28, 6272
    buffer_load_dwordx4 v1, s[12:15], s31 offen offset:0 nt lds
    s_barrier
    ds_read_b128 v[224:227], v20 offset:0
    ds_read_b128 v[228:231], v21 offset:0
    ds_read_b128 v[232:235], v20 offset:4096
    ds_read_b128 v[236:239], v21 offset:4096
    s_waitcnt lgkmcnt(2)
    s_waitcnt vmcnt(4)
    v_xor_b32 v44, 64, v4
    ds_read_b128 v[32:35], v4 offset:32768
    ds_read_b128 v[36:39], v4 offset:34816
    ds_read_b128 v[40:43], v44 offset:32768
    ds_read_b128 v[44:47], v44 offset:34816
    s_add_u32 m0, s30, 16384
    s_add_u32 s31, s28, 16384
    buffer_load_dwordx4 v2, s[16:19], s31 offen offset:0 nt lds
    s_add_u32 m0, s30, 24576
    s_add_u32 s31, s28, 24576
    buffer_load_dwordx4 v2, s[16:19], s31 offen offset:0 nt lds
    s_waitcnt lgkmcnt(0)
    s_add_u32 m0, s35, 131072
    s_add_u32 s31, s29, 0
    buffer_load_dwordx4 v1, s[12:15], s31 offen offset:0 nt lds
    s_add_u32 m0, s35, 132096
    s_add_u32 s31, s29, 2048
    buffer_load_dwordx4 v1, s[12:15], s31 offen offset:0 nt lds
    v_mfma_f32_16x16x32_bf16 v[96:99], v[224:227], v[32:35], 0
    ds_read_b128 v[240:243], v20 offset:8192
    v_mfma_f32_16x16x32_bf16 v[96:99], v[228:231], v[40:43], v[96:99]
    ds_read_b128 v[244:247], v21 offset:8192
    v_mfma_f32_16x16x32_bf16 v[104:107], v[224:227], v[36:39], 0
    ds_read_b128 v[248:251], v20 offset:12288
    v_mfma_f32_16x16x32_bf16 v[104:107], v[228:231], v[44:47], v[104:107]
    ds_read_b128 v[224:227], v21 offset:12288
    v_mfma_f32_16x16x32_bf16 v[100:103], v[232:235], v[32:35], 0
    v_mfma_f32_16x16x32_bf16 v[100:103], v[236:239], v[40:43], v[100:103]
    v_mfma_f32_16x16x32_bf16 v[108:111], v[232:235], v[36:39], 0
    ds_read_b128 v[228:231], v22 offset:0
    v_mfma_f32_16x16x32_bf16 v[108:111], v[236:239], v[44:47], v[108:111]
    ds_read_b128 v[232:235], v23 offset:0
    s_waitcnt lgkmcnt(4)
    v_mfma_f32_16x16x32_bf16 v[112:115], v[240:243], v[32:35], 0
    v_mfma_f32_16x16x32_bf16 v[112:115], v[244:247], v[40:43], v[112:115]
    v_mfma_f32_16x16x32_bf16 v[120:123], v[240:243], v[36:39], 0
    ds_read_b128 v[236:239], v22 offset:4096
    v_mfma_f32_16x16x32_bf16 v[120:123], v[244:247], v[44:47], v[120:123]
    ds_read_b128 v[240:243], v23 offset:4096
    s_waitcnt lgkmcnt(4)
    v_mfma_f32_16x16x32_bf16 v[116:119], v[248:251], v[32:35], 0
    v_mfma_f32_16x16x32_bf16 v[116:119], v[224:227], v[40:43], v[116:119]
    v_mfma_f32_16x16x32_bf16 v[124:127], v[248:251], v[36:39], 0
    ds_read_b128 v[244:247], v22 offset:8192
    v_mfma_f32_16x16x32_bf16 v[124:127], v[224:227], v[44:47], v[124:127]
    ds_read_b128 v[248:251], v23 offset:8192
    s_waitcnt lgkmcnt(4)
    s_waitcnt vmcnt(4)
    v_xor_b32 v60, 64, v4
    ds_read_b128 v[48:51], v4 offset:0
    ds_read_b128 v[52:55], v4 offset:2048
    ds_read_b128 v[56:59], v60 offset:0
    ds_read_b128 v[60:63], v60 offset:2048
    s_add_u32 m0, s30, 65536
    s_add_u32 s31, s28, 0
    buffer_load_dwordx4 v3, s[20:23], s31 offen offset:0 nt lds
    s_add_u32 m0, s30, 73728
    s_add_u32 s31, s28, 8192
    buffer_load_dwordx4 v3, s[20:23], s31 offen offset:0 nt lds
    s_add_u32 m0, s35, 133120
    s_add_u32 s31, s29, 4096
    buffer_load_dwordx4 v1, s[12:15], s31 offen offset:0 nt lds
    s_add_u32 m0, s35, 134144
    s_add_u32 s31, s29, 6144
    buffer_load_dwordx4 v1, s[12:15], s31 offen offset:0 nt lds
    s_waitcnt lgkmcnt(3)
    v_mfma_f32_16x16x32_bf16 v[96:99], v[228:231], v[48:51], v[96:99]
    s_waitcnt lgkmcnt(1)
    v_mfma_f32_16x16x32_bf16 v[96:99], v[232:235], v[56:59], v[96:99]
    v_mfma_f32_16x16x32_bf16 v[104:107], v[228:231], v[52:55], v[104:107]
    ds_read_b128 v[224:227], v22 offset:12288
    s_waitcnt lgkmcnt(1)
    v_mfma_f32_16x16x32_bf16 v[104:107], v[232:235], v[60:63], v[104:107]
    ds_read_b128 v[228:231], v23 offset:12288
    v_mfma_f32_16x16x32_bf16 v[100:103], v[236:239], v[48:51], v[100:103]
    v_mfma_f32_16x16x32_bf16 v[100:103], v[240:243], v[56:59], v[100:103]
    v_mfma_f32_16x16x32_bf16 v[108:111], v[236:239], v[52:55], v[108:111]
    v_mfma_f32_16x16x32_bf16 v[108:111], v[240:243], v[60:63], v[108:111]
    v_mfma_f32_16x16x32_bf16 v[112:115], v[244:247], v[48:51], v[112:115]
    v_mfma_f32_16x16x32_bf16 v[112:115], v[248:251], v[56:59], v[112:115]
    v_mfma_f32_16x16x32_bf16 v[120:123], v[244:247], v[52:55], v[120:123]
    v_mfma_f32_16x16x32_bf16 v[120:123], v[248:251], v[60:63], v[120:123]
    s_waitcnt lgkmcnt(0)
    v_mfma_f32_16x16x32_bf16 v[116:119], v[224:227], v[48:51], v[116:119]
    v_mfma_f32_16x16x32_bf16 v[116:119], v[228:231], v[56:59], v[116:119]
    v_mfma_f32_16x16x32_bf16 v[124:127], v[224:227], v[52:55], v[124:127]
    v_mfma_f32_16x16x32_bf16 v[124:127], v[228:231], v[60:63], v[124:127]
    v_max_f32 v0, v96, v97
    v_max_f32 v5, v104, v105
    v_max3_f32 v0, v0, v98, v99
    v_max3_f32 v5, v5, v106, v107
    v_max3_f32 v0, v0, v100, v101
    v_max3_f32 v5, v5, v108, v109
    v_max3_f32 v0, v0, v102, v103
    v_max3_f32 v5, v5, v110, v111
    v_max3_f32 v0, v0, v112, v113
    v_max3_f32 v5, v5, v120, v121
    v_max3_f32 v0, v0, v114, v115
    v_max3_f32 v5, v5, v122, v123
    v_max3_f32 v0, v0, v116, v117
    v_max3_f32 v5, v5, v124, v125
    v_max3_f32 v0, v0, v118, v119
    v_max3_f32 v5, v5, v126, v127
    s_nop 1
    v_permlane32_swap_b32 v0, v5
    v_max_f32 v0, v0, v5
    v_mov_b32 v5, v0
    s_nop 1
    v_permlane16_swap_b32 v0, v5
    v_max_f32 v0, v0, v5
    v_mul_f32 v253, s41, v0
    v_mul_f32 v254, s41, v0
    s_nop 1
    v_permlane32_swap_b32 v253, v254
    v_fmamk_f32 v96, v96, 0x3e0293ee, v253
    v_fmamk_f32 v97, v97, 0x3e0293ee, v253
    v_fmamk_f32 v98, v98, 0x3e0293ee, v253
    v_exp_f32 v96, v96
    v_fmamk_f32 v99, v99, 0x3e0293ee, v253
    v_exp_f32 v97, v97
    v_fmamk_f32 v100, v100, 0x3e0293ee, v253
    v_exp_f32 v98, v98
    v_fmamk_f32 v101, v101, 0x3e0293ee, v253
    v_exp_f32 v99, v99
    v_cvt_pk_bf16_f32 v96, v96, v97
    v_fmamk_f32 v102, v102, 0x3e0293ee, v253
    v_exp_f32 v100, v100
    v_fmamk_f32 v103, v103, 0x3e0293ee, v253
    s_add_u32 m0, s30, 32768
    s_add_u32 s31, s28, 32768
    buffer_load_dwordx4 v2, s[16:19], s31 offen offset:0 nt lds
    v_exp_f32 v101, v101
    v_cvt_pk_bf16_f32 v97, v98, v99
    v_fmamk_f32 v104, v104, 0x3e0293ee, v254
    v_exp_f32 v102, v102
    v_fmamk_f32 v105, v105, 0x3e0293ee, v254
    v_exp_f32 v103, v103
    v_cvt_pk_bf16_f32 v98, v100, v101
    v_fmamk_f32 v106, v106, 0x3e0293ee, v254
    v_exp_f32 v104, v104
    v_fmamk_f32 v107, v107, 0x3e0293ee, v254
    v_exp_f32 v105, v105
    v_cvt_pk_bf16_f32 v99, v102, v103
    v_fmamk_f32 v108, v108, 0x3e0293ee, v254
    v_exp_f32 v106, v106
    v_fmamk_f32 v109, v109, 0x3e0293ee, v254
    v_exp_f32 v107, v107
    v_cvt_pk_bf16_f32 v100, v104, v105
    v_fmamk_f32 v110, v110, 0x3e0293ee, v254
    v_exp_f32 v108, v108
    v_fmamk_f32 v111, v111, 0x3e0293ee, v254
    v_exp_f32 v109, v109
    v_cvt_pk_bf16_f32 v101, v106, v107
    v_fmamk_f32 v112, v112, 0x3e0293ee, v253
    v_exp_f32 v110, v110
    v_fmamk_f32 v113, v113, 0x3e0293ee, v253
    v_exp_f32 v111, v111
    v_cvt_pk_bf16_f32 v102, v108, v109
    v_fmamk_f32 v114, v114, 0x3e0293ee, v253
    v_exp_f32 v112, v112
    v_fmamk_f32 v115, v115, 0x3e0293ee, v253
    s_add_u32 m0, s30, 40960
    s_add_u32 s31, s28, 40960
    buffer_load_dwordx4 v2, s[16:19], s31 offen offset:0 nt lds
    v_exp_f32 v113, v113
    v_cvt_pk_bf16_f32 v103, v110, v111
    v_fmamk_f32 v116, v116, 0x3e0293ee, v253
    v_exp_f32 v114, v114
    v_fmamk_f32 v117, v117, 0x3e0293ee, v253
    v_exp_f32 v115, v115
    v_cvt_pk_bf16_f32 v104, v112, v113
    v_fmamk_f32 v118, v118, 0x3e0293ee, v253
    v_exp_f32 v116, v116
    v_fmamk_f32 v119, v119, 0x3e0293ee, v253
    v_exp_f32 v117, v117
    v_cvt_pk_bf16_f32 v105, v114, v115
    v_fmamk_f32 v120, v120, 0x3e0293ee, v254
    v_exp_f32 v118, v118
    v_fmamk_f32 v121, v121, 0x3e0293ee, v254
    v_exp_f32 v119, v119
    v_cvt_pk_bf16_f32 v106, v116, v117
    v_fmamk_f32 v122, v122, 0x3e0293ee, v254
    v_exp_f32 v120, v120
    v_fmamk_f32 v123, v123, 0x3e0293ee, v254
    v_exp_f32 v121, v121
    v_cvt_pk_bf16_f32 v107, v118, v119
    v_fmamk_f32 v124, v124, 0x3e0293ee, v254
    v_exp_f32 v122, v122
    v_fmamk_f32 v125, v125, 0x3e0293ee, v254
    v_exp_f32 v123, v123
    v_cvt_pk_bf16_f32 v108, v120, v121
    v_fmamk_f32 v126, v126, 0x3e0293ee, v254
    v_exp_f32 v124, v124
    v_fmamk_f32 v127, v127, 0x3e0293ee, v254
    v_exp_f32 v125, v125
    v_cvt_pk_bf16_f32 v109, v122, v123
    v_exp_f32 v126, v126
    v_exp_f32 v127, v127
    v_cvt_pk_bf16_f32 v110, v124, v125
    v_cvt_pk_bf16_f32 v111, v126, v127
    s_waitcnt vmcnt(8)
    s_barrier
    ds_read_b128 v[232:235], v20 offset:16384
    ds_read_b128 v[236:239], v21 offset:16384
    ds_read_b128 v[240:243], v22 offset:16384
    ds_read_b128 v[244:247], v23 offset:16384
    ds_read_b128 v[248:251], v20 offset:20480
    ds_read_b128 v[224:227], v21 offset:20480
    ds_read_b128 v[228:231], v22 offset:20480
    s_waitcnt lgkmcnt(5)
    v_mfma_f32_16x16x32_bf16 v[128:131], v[232:235], v[32:35], 0
    v_mfma_f32_16x16x32_bf16 v[128:131], v[236:239], v[40:43], v[128:131]
    s_waitcnt lgkmcnt(3)
    v_mfma_f32_16x16x32_bf16 v[128:131], v[240:243], v[48:51], v[128:131]
    v_mfma_f32_16x16x32_bf16 v[128:131], v[244:247], v[56:59], v[128:131]
    v_mfma_f32_16x16x32_bf16 v[136:139], v[232:235], v[36:39], 0
    ds_read_b128 v[232:235], v23 offset:20480
    v_mfma_f32_16x16x32_bf16 v[136:139], v[236:239], v[44:47], v[136:139]
    v_mfma_f32_16x16x32_bf16 v[136:139], v[240:243], v[52:55], v[136:139]
    ds_read_b128 v[236:239], v20 offset:24576
    v_mfma_f32_16x16x32_bf16 v[136:139], v[244:247], v[60:63], v[136:139]
    ds_read_b128 v[240:243], v21 offset:24576
    s_waitcnt lgkmcnt(4)
    v_mfma_f32_16x16x32_bf16 v[132:135], v[248:251], v[32:35], 0
    ds_read_b128 v[244:247], v22 offset:24576
    v_mfma_f32_16x16x32_bf16 v[132:135], v[224:227], v[40:43], v[132:135]
    s_waitcnt lgkmcnt(3)
    v_mfma_f32_16x16x32_bf16 v[132:135], v[228:231], v[48:51], v[132:135]
    v_mfma_f32_16x16x32_bf16 v[132:135], v[232:235], v[56:59], v[132:135]
    s_add_u32 m0, s30, 49152
    s_add_u32 s31, s28, 49152
    buffer_load_dwordx4 v2, s[16:19], s31 offen offset:0 nt lds
    v_mfma_f32_16x16x32_bf16 v[140:143], v[248:251], v[36:39], 0
    ds_read_b128 v[248:251], v23 offset:24576
    v_mfma_f32_16x16x32_bf16 v[140:143], v[224:227], v[44:47], v[140:143]
    v_mfma_f32_16x16x32_bf16 v[140:143], v[228:231], v[52:55], v[140:143]
    ds_read_b128 v[224:227], v20 offset:28672
    v_mfma_f32_16x16x32_bf16 v[140:143], v[232:235], v[60:63], v[140:143]
    ds_read_b128 v[228:231], v21 offset:28672
    s_waitcnt lgkmcnt(4)
    v_mfma_f32_16x16x32_bf16 v[144:147], v[236:239], v[32:35], 0
    ds_read_b128 v[232:235], v22 offset:28672
    s_add_u32 m0, s30, 57344
    s_add_u32 s31, s28, 57344
    buffer_load_dwordx4 v2, s[16:19], s31 offen offset:0 nt lds
    v_mfma_f32_16x16x32_bf16 v[144:147], v[240:243], v[40:43], v[144:147]
    s_waitcnt lgkmcnt(3)
    v_mfma_f32_16x16x32_bf16 v[144:147], v[244:247], v[48:51], v[144:147]
    v_fmamk_f32 v128, v128, 0x3e0293ee, v253
    v_fmamk_f32 v129, v129, 0x3e0293ee, v253
    v_fmamk_f32 v130, v130, 0x3e0293ee, v253
    v_exp_f32 v128, v128
    v_fmamk_f32 v131, v131, 0x3e0293ee, v253
    v_exp_f32 v129, v129
    v_fmamk_f32 v132, v132, 0x3e0293ee, v253
    v_exp_f32 v130, v130
    v_fmamk_f32 v133, v133, 0x3e0293ee, v253
    v_exp_f32 v131, v131
    v_cvt_pk_bf16_f32 v128, v128, v129
    v_fmamk_f32 v134, v134, 0x3e0293ee, v253
    v_exp_f32 v132, v132
    v_fmamk_f32 v135, v135, 0x3e0293ee, v253
    v_exp_f32 v133, v133
    v_cvt_pk_bf16_f32 v129, v130, v131
    v_fmamk_f32 v136, v136, 0x3e0293ee, v254
    v_exp_f32 v134, v134
    v_fmamk_f32 v137, v137, 0x3e0293ee, v254
    v_exp_f32 v135, v135
    v_cvt_pk_bf16_f32 v130, v132, v133
    v_fmamk_f32 v138, v138, 0x3e0293ee, v254
    v_exp_f32 v136, v136
    v_fmamk_f32 v139, v139, 0x3e0293ee, v254
    v_exp_f32 v137, v137
    v_cvt_pk_bf16_f32 v131, v134, v135
    v_fmamk_f32 v140, v140, 0x3e0293ee, v254
    v_exp_f32 v138, v138
    v_fmamk_f32 v141, v141, 0x3e0293ee, v254
    v_exp_f32 v139, v139
    v_cvt_pk_bf16_f32 v132, v136, v137
    v_fmamk_f32 v142, v142, 0x3e0293ee, v254
    v_exp_f32 v140, v140
    v_fmamk_f32 v143, v143, 0x3e0293ee, v254
    v_exp_f32 v141, v141
    v_cvt_pk_bf16_f32 v133, v138, v139
    v_mfma_f32_16x16x32_bf16 v[144:147], v[248:251], v[56:59], v[144:147]
    v_mfma_f32_16x16x32_bf16 v[152:155], v[236:239], v[36:39], 0
    ds_read_b128 v[236:239], v23 offset:28672
    v_mfma_f32_16x16x32_bf16 v[152:155], v[240:243], v[44:47], v[152:155]
    v_mfma_f32_16x16x32_bf16 v[152:155], v[244:247], v[52:55], v[152:155]
    s_waitcnt vmcnt(6)
    s_barrier
    ds_read_b64_tr_b16 v[240:241], v24 offset:0
    ds_read_b64_tr_b16 v[242:243], v24 offset:4096
    s_add_u32 m0, s30, 81920
    s_add_u32 s31, s28, 16384
    buffer_load_dwordx4 v3, s[20:23], s31 offen offset:0 nt lds
    v_mfma_f32_16x16x32_bf16 v[152:155], v[248:251], v[60:63], v[152:155]
    ds_read_b64_tr_b16 v[244:245], v24 offset:8192
    ds_read_b64_tr_b16 v[246:247], v24 offset:12288
    s_waitcnt lgkmcnt(6)
    v_mfma_f32_16x16x32_bf16 v[148:151], v[224:227], v[32:35], 0
    v_mfma_f32_16x16x32_bf16 v[148:151], v[228:231], v[40:43], v[148:151]
    s_waitcnt lgkmcnt(4)
    v_mfma_f32_16x16x32_bf16 v[148:151], v[232:235], v[48:51], v[148:151]
    v_mfma_f32_16x16x32_bf16 v[148:151], v[236:239], v[56:59], v[148:151]
    v_mfma_f32_16x16x32_bf16 v[156:159], v[224:227], v[36:39], 0
    v_mfma_f32_16x16x32_bf16 v[156:159], v[228:231], v[44:47], v[156:159]
    v_mfma_f32_16x16x32_bf16 v[156:159], v[232:235], v[52:55], v[156:159]
    ds_read_b64_tr_b16 v[248:249], v25 offset:0
    ds_read_b64_tr_b16 v[250:251], v25 offset:4096
    v_mfma_f32_16x16x32_bf16 v[156:159], v[236:239], v[60:63], v[156:159]
    ds_read_b64_tr_b16 v[224:225], v25 offset:8192
    ds_read_b64_tr_b16 v[226:227], v25 offset:12288
    s_add_u32 m0, s30, 90112
    s_add_u32 s31, s28, 24576
    buffer_load_dwordx4 v3, s[20:23], s31 offen offset:0 nt lds
    s_waitcnt lgkmcnt(4)
    v_mfma_f32_16x16x32_bf16 v[160:163], v[240:243], v[96:99], 0
    v_mfma_f32_16x16x32_bf16 v[160:163], v[244:247], v[104:107], v[160:163]
    v_mfma_f32_16x16x32_bf16 v[164:167], v[240:243], v[100:103], 0
    ds_read_b64_tr_b16 v[228:229], v26 offset:0
    ds_read_b64_tr_b16 v[230:231], v26 offset:4096
    v_fmamk_f32 v144, v144, 0x3e0293ee, v253
    v_exp_f32 v142, v142
    v_fmamk_f32 v145, v145, 0x3e0293ee, v253
    v_exp_f32 v143, v143
    v_cvt_pk_bf16_f32 v134, v140, v141
    v_fmamk_f32 v146, v146, 0x3e0293ee, v253
    v_exp_f32 v144, v144
    v_fmamk_f32 v147, v147, 0x3e0293ee, v253
    v_exp_f32 v145, v145
    v_cvt_pk_bf16_f32 v135, v142, v143
    v_fmamk_f32 v148, v148, 0x3e0293ee, v253
    v_exp_f32 v146, v146
    v_fmamk_f32 v149, v149, 0x3e0293ee, v253
    v_exp_f32 v147, v147
    v_cvt_pk_bf16_f32 v136, v144, v145
    v_fmamk_f32 v150, v150, 0x3e0293ee, v253
    v_exp_f32 v148, v148
    v_fmamk_f32 v151, v151, 0x3e0293ee, v253
    v_exp_f32 v149, v149
    v_cvt_pk_bf16_f32 v137, v146, v147
    v_fmamk_f32 v152, v152, 0x3e0293ee, v254
    v_exp_f32 v150, v150
    v_fmamk_f32 v153, v153, 0x3e0293ee, v254
    v_exp_f32 v151, v151
    v_cvt_pk_bf16_f32 v138, v148, v149
    v_fmamk_f32 v154, v154, 0x3e0293ee, v254
    v_exp_f32 v152, v152
    v_fmamk_f32 v155, v155, 0x3e0293ee, v254
    v_exp_f32 v153, v153
    v_cvt_pk_bf16_f32 v139, v150, v151
    v_fmamk_f32 v156, v156, 0x3e0293ee, v254
    v_exp_f32 v154, v154
    v_fmamk_f32 v157, v157, 0x3e0293ee, v254
    v_exp_f32 v155, v155
    v_cvt_pk_bf16_f32 v140, v152, v153
    v_fmamk_f32 v158, v158, 0x3e0293ee, v254
    v_exp_f32 v156, v156
    v_mfma_f32_16x16x32_bf16 v[164:167], v[244:247], v[108:111], v[164:167]
    ds_read_b64_tr_b16 v[232:233], v26 offset:8192
    ds_read_b64_tr_b16 v[234:235], v26 offset:12288
    v_fmamk_f32 v159, v159, 0x3e0293ee, v254
    v_exp_f32 v157, v157
    v_cvt_pk_bf16_f32 v141, v154, v155
    v_exp_f32 v158, v158
    v_exp_f32 v159, v159
    v_cvt_pk_bf16_f32 v142, v156, v157
    v_cvt_pk_bf16_f32 v143, v158, v159
    v_mfma_f32_16x16x32_bf16 v[12:15], v[8:11], v[96:99], 0
    v_mfma_f32_16x16x32_bf16 v[12:15], v[8:11], v[104:107], v[12:15]
    v_mfma_f32_16x16x32_bf16 v[16:19], v[8:11], v[100:103], 0
    ds_read_b64_tr_b16 v[236:237], v27 offset:0
    ds_read_b64_tr_b16 v[238:239], v27 offset:4096
    v_mfma_f32_16x16x32_bf16 v[16:19], v[8:11], v[108:111], v[16:19]
    ds_read_b64_tr_b16 v[240:241], v27 offset:8192
    ds_read_b64_tr_b16 v[242:243], v27 offset:12288
    s_waitcnt lgkmcnt(8)
    v_mfma_f32_16x16x32_bf16 v[168:171], v[248:251], v[96:99], 0
    v_mfma_f32_16x16x32_bf16 v[168:171], v[224:227], v[104:107], v[168:171]
    v_mfma_f32_16x16x32_bf16 v[172:175], v[248:251], v[100:103], 0
    ds_read_b64_tr_b16 v[244:245], v28 offset:0
    ds_read_b64_tr_b16 v[246:247], v28 offset:4096
    v_mfma_f32_16x16x32_bf16 v[172:175], v[224:227], v[108:111], v[172:175]
    ds_read_b64_tr_b16 v[248:249], v28 offset:8192
    ds_read_b64_tr_b16 v[250:251], v28 offset:12288
    s_waitcnt lgkmcnt(8)
    v_mfma_f32_16x16x32_bf16 v[176:179], v[228:231], v[96:99], 0
    v_mfma_f32_16x16x32_bf16 v[176:179], v[232:235], v[104:107], v[176:179]
    v_mfma_f32_16x16x32_bf16 v[180:183], v[228:231], v[100:103], 0
    ds_read_b64_tr_b16 v[224:225], v29 offset:0
    ds_read_b64_tr_b16 v[226:227], v29 offset:4096
    v_mfma_f32_16x16x32_bf16 v[180:183], v[232:235], v[108:111], v[180:183]
    ds_read_b64_tr_b16 v[228:229], v29 offset:8192
    ds_read_b64_tr_b16 v[230:231], v29 offset:12288
    s_waitcnt lgkmcnt(8)
    v_mfma_f32_16x16x32_bf16 v[184:187], v[236:239], v[96:99], 0
    v_mfma_f32_16x16x32_bf16 v[184:187], v[240:243], v[104:107], v[184:187]
    v_mfma_f32_16x16x32_bf16 v[188:191], v[236:239], v[100:103], 0
    ds_read_b64_tr_b16 v[232:233], v30 offset:0
    ds_read_b64_tr_b16 v[234:235], v30 offset:4096
    v_mfma_f32_16x16x32_bf16 v[188:191], v[240:243], v[108:111], v[188:191]
    ds_read_b64_tr_b16 v[236:237], v30 offset:8192
    ds_read_b64_tr_b16 v[238:239], v30 offset:12288
    s_waitcnt lgkmcnt(8)
    v_mfma_f32_16x16x32_bf16 v[192:195], v[244:247], v[96:99], 0
    v_mfma_f32_16x16x32_bf16 v[192:195], v[248:251], v[104:107], v[192:195]
    v_mfma_f32_16x16x32_bf16 v[196:199], v[244:247], v[100:103], 0
    ds_read_b64_tr_b16 v[240:241], v31 offset:0
    ds_read_b64_tr_b16 v[242:243], v31 offset:4096
    v_mfma_f32_16x16x32_bf16 v[196:199], v[248:251], v[108:111], v[196:199]
    ds_read_b64_tr_b16 v[244:245], v31 offset:8192
    ds_read_b64_tr_b16 v[246:247], v31 offset:12288
    s_waitcnt lgkmcnt(8)
    v_mfma_f32_16x16x32_bf16 v[200:203], v[224:227], v[96:99], 0
    v_mfma_f32_16x16x32_bf16 v[200:203], v[228:231], v[104:107], v[200:203]
    v_mfma_f32_16x16x32_bf16 v[204:207], v[224:227], v[100:103], 0
    s_waitcnt vmcnt(4)
    s_barrier
    ds_read_b128 v[248:251], v20 offset:32768
    v_mfma_f32_16x16x32_bf16 v[204:207], v[228:231], v[108:111], v[204:207]
    ds_read_b128 v[224:227], v21 offset:32768
    s_waitcnt lgkmcnt(6)
    v_mfma_f32_16x16x32_bf16 v[208:211], v[232:235], v[96:99], 0
    ds_read_b128 v[228:231], v22 offset:32768
    v_mfma_f32_16x16x32_bf16 v[208:211], v[236:239], v[104:107], v[208:211]
    v_mfma_f32_16x16x32_bf16 v[212:215], v[232:235], v[100:103], 0
    ds_read_b128 v[232:235], v23 offset:32768
    v_mfma_f32_16x16x32_bf16 v[212:215], v[236:239], v[108:111], v[212:215]
    s_waitcnt lgkmcnt(4)
    v_mfma_f32_16x16x32_bf16 v[216:219], v[240:243], v[96:99], 0
    v_mfma_f32_16x16x32_bf16 v[216:219], v[244:247], v[104:107], v[216:219]
    v_mfma_f32_16x16x32_bf16 v[220:223], v[240:243], v[100:103], 0
    ds_read_b128 v[236:239], v20 offset:36864
    v_mfma_f32_16x16x32_bf16 v[220:223], v[244:247], v[108:111], v[220:223]
    ds_read_b128 v[240:243], v21 offset:36864
    s_waitcnt lgkmcnt(4)
    v_mfma_f32_16x16x32_bf16 v[96:99], v[248:251], v[32:35], 0
    ds_read_b128 v[244:247], v22 offset:36864
    v_xor_b32 v76, 64, v4
    ds_read_b128 v[64:67], v4 offset:32768
    ds_read_b128 v[68:71], v4 offset:34816
    ds_read_b128 v[72:75], v76 offset:32768
    ds_read_b128 v[76:79], v76 offset:34816
    v_mfma_f32_16x16x32_bf16 v[96:99], v[224:227], v[40:43], v[96:99]
    s_waitcnt lgkmcnt(7)
    v_mfma_f32_16x16x32_bf16 v[96:99], v[228:231], v[48:51], v[96:99]
    v_mfma_f32_16x16x32_bf16 v[96:99], v[232:235], v[56:59], v[96:99]
    v_mfma_f32_16x16x32_bf16 v[104:107], v[248:251], v[36:39], 0
    ds_read_b128 v[248:251], v23 offset:36864
    v_mfma_f32_16x16x32_bf16 v[104:107], v[224:227], v[44:47], v[104:107]
    s_waitcnt lgkmcnt(1)
    s_add_u32 m0, s35, 131072
    s_add_u32 s31, s29, 128
    buffer_load_dwordx4 v1, s[12:15], s31 offen offset:0 nt lds
    v_mfma_f32_16x16x32_bf16 v[104:107], v[228:231], v[52:55], v[104:107]
    ds_read_b128 v[224:227], v20 offset:40960
    v_mfma_f32_16x16x32_bf16 v[104:107], v[232:235], v[60:63], v[104:107]
    ds_read_b128 v[228:231], v21 offset:40960
    s_add_u32 m0, s35, 132096
    s_add_u32 s31, s29, 2176
    buffer_load_dwordx4 v1, s[12:15], s31 offen offset:0 nt lds
    v_mfma_f32_16x16x32_bf16 v[100:103], v[236:239], v[32:35], 0
    ds_read_b128 v[232:235], v22 offset:40960
    v_mfma_f32_16x16x32_bf16 v[100:103], v[240:243], v[40:43], v[100:103]
    s_add_u32 m0, s30, 98304
    s_add_u32 s31, s28, 32768
    buffer_load_dwordx4 v3, s[20:23], s31 offen offset:0 nt lds
    s_waitcnt lgkmcnt(3)
    v_mfma_f32_16x16x32_bf16 v[100:103], v[244:247], v[48:51], v[100:103]
    v_mfma_f32_16x16x32_bf16 v[100:103], v[248:251], v[56:59], v[100:103]
    s_add_u32 m0, s30, 106496
    s_add_u32 s31, s28, 40960
    buffer_load_dwordx4 v3, s[20:23], s31 offen offset:0 nt lds
    v_mfma_f32_16x16x32_bf16 v[108:111], v[236:239], v[36:39], 0
    ds_read_b128 v[236:239], v23 offset:40960
    v_mfma_f32_16x16x32_bf16 v[108:111], v[240:243], v[44:47], v[108:111]
    s_add_u32 m0, s35, 133120
    s_add_u32 s31, s29, 4224
    buffer_load_dwordx4 v1, s[12:15], s31 offen offset:0 nt lds
    v_mfma_f32_16x16x32_bf16 v[108:111], v[244:247], v[52:55], v[108:111]
    ds_read_b128 v[240:243], v20 offset:45056
    v_mfma_f32_16x16x32_bf16 v[108:111], v[248:251], v[60:63], v[108:111]
    ds_read_b128 v[244:247], v21 offset:45056
    s_waitcnt lgkmcnt(4)
    v_mfma_f32_16x16x32_bf16 v[112:115], v[224:227], v[32:35], 0
    ds_read_b128 v[248:251], v22 offset:45056
    s_add_u32 m0, s35, 134144
    s_add_u32 s31, s29, 6272
    buffer_load_dwordx4 v1, s[12:15], s31 offen offset:0 nt lds
    v_mfma_f32_16x16x32_bf16 v[112:115], v[228:231], v[40:43], v[112:115]
    s_waitcnt lgkmcnt(3)
    v_mfma_f32_16x16x32_bf16 v[112:115], v[232:235], v[48:51], v[112:115]
    v_fmamk_f32 v96, v96, 0x3e0293ee, v253
    v_fmamk_f32 v97, v97, 0x3e0293ee, v253
    v_fmamk_f32 v98, v98, 0x3e0293ee, v253
    v_exp_f32 v96, v96
    v_fmamk_f32 v99, v99, 0x3e0293ee, v253
    v_exp_f32 v97, v97
    v_fmamk_f32 v100, v100, 0x3e0293ee, v253
    v_exp_f32 v98, v98
    v_fmamk_f32 v101, v101, 0x3e0293ee, v253
    v_exp_f32 v99, v99
    v_cvt_pk_bf16_f32 v96, v96, v97
    v_fmamk_f32 v102, v102, 0x3e0293ee, v253
    v_exp_f32 v100, v100
    v_fmamk_f32 v103, v103, 0x3e0293ee, v253
    v_exp_f32 v101, v101
    v_cvt_pk_bf16_f32 v97, v98, v99
    v_fmamk_f32 v104, v104, 0x3e0293ee, v254
    v_exp_f32 v102, v102
    v_fmamk_f32 v105, v105, 0x3e0293ee, v254
    v_exp_f32 v103, v103
    v_cvt_pk_bf16_f32 v98, v100, v101
    v_fmamk_f32 v106, v106, 0x3e0293ee, v254
    v_exp_f32 v104, v104
    v_fmamk_f32 v107, v107, 0x3e0293ee, v254
    v_exp_f32 v105, v105
    v_cvt_pk_bf16_f32 v99, v102, v103
    v_fmamk_f32 v108, v108, 0x3e0293ee, v254
    v_exp_f32 v106, v106
    v_fmamk_f32 v109, v109, 0x3e0293ee, v254
    v_exp_f32 v107, v107
    v_cvt_pk_bf16_f32 v100, v104, v105
    v_fmamk_f32 v110, v110, 0x3e0293ee, v254
    v_exp_f32 v108, v108
    v_fmamk_f32 v111, v111, 0x3e0293ee, v254
    v_exp_f32 v109, v109
    v_cvt_pk_bf16_f32 v101, v106, v107
    v_mfma_f32_16x16x32_bf16 v[112:115], v[236:239], v[56:59], v[112:115]
    v_mfma_f32_16x16x32_bf16 v[120:123], v[224:227], v[36:39], 0
    ds_read_b128 v[224:227], v23 offset:45056
    v_mfma_f32_16x16x32_bf16 v[120:123], v[228:231], v[44:47], v[120:123]
    v_mfma_f32_16x16x32_bf16 v[120:123], v[232:235], v[52:55], v[120:123]
    s_waitcnt vmcnt(6)
    s_barrier
    ds_read_b64_tr_b16 v[228:229], v24 offset:16384
    ds_read_b64_tr_b16 v[230:231], v24 offset:20480
    v_mfma_f32_16x16x32_bf16 v[120:123], v[236:239], v[60:63], v[120:123]
    ds_read_b64_tr_b16 v[232:233], v24 offset:24576
    ds_read_b64_tr_b16 v[234:235], v24 offset:28672
    s_waitcnt lgkmcnt(6)
    v_mfma_f32_16x16x32_bf16 v[116:119], v[240:243], v[32:35], 0
    v_mfma_f32_16x16x32_bf16 v[116:119], v[244:247], v[40:43], v[116:119]
    s_waitcnt lgkmcnt(4)
    v_mfma_f32_16x16x32_bf16 v[116:119], v[248:251], v[48:51], v[116:119]
    v_mfma_f32_16x16x32_bf16 v[116:119], v[224:227], v[56:59], v[116:119]
    v_mfma_f32_16x16x32_bf16 v[124:127], v[240:243], v[36:39], 0
    v_mfma_f32_16x16x32_bf16 v[124:127], v[244:247], v[44:47], v[124:127]
    v_mfma_f32_16x16x32_bf16 v[124:127], v[248:251], v[52:55], v[124:127]
    ds_read_b64_tr_b16 v[236:237], v25 offset:16384
    ds_read_b64_tr_b16 v[238:239], v25 offset:20480
    v_mfma_f32_16x16x32_bf16 v[124:127], v[224:227], v[60:63], v[124:127]
    ds_read_b64_tr_b16 v[240:241], v25 offset:24576
    ds_read_b64_tr_b16 v[242:243], v25 offset:28672
    s_waitcnt lgkmcnt(4)
    v_mfma_f32_16x16x32_bf16 v[160:163], v[228:231], v[128:131], v[160:163]
    v_mfma_f32_16x16x32_bf16 v[160:163], v[232:235], v[136:139], v[160:163]
    v_mfma_f32_16x16x32_bf16 v[164:167], v[228:231], v[132:135], v[164:167]
    ds_read_b64_tr_b16 v[244:245], v26 offset:16384
    ds_read_b64_tr_b16 v[246:247], v26 offset:20480
    v_fmamk_f32 v112, v112, 0x3e0293ee, v253
    v_exp_f32 v110, v110
    v_fmamk_f32 v113, v113, 0x3e0293ee, v253
    v_exp_f32 v111, v111
    v_cvt_pk_bf16_f32 v102, v108, v109
    v_fmamk_f32 v114, v114, 0x3e0293ee, v253
    v_exp_f32 v112, v112
    v_fmamk_f32 v115, v115, 0x3e0293ee, v253
    v_exp_f32 v113, v113
    v_cvt_pk_bf16_f32 v103, v110, v111
    v_fmamk_f32 v116, v116, 0x3e0293ee, v253
    v_exp_f32 v114, v114
    v_fmamk_f32 v117, v117, 0x3e0293ee, v253
    v_exp_f32 v115, v115
    v_cvt_pk_bf16_f32 v104, v112, v113
    v_fmamk_f32 v118, v118, 0x3e0293ee, v253
    v_exp_f32 v116, v116
    v_fmamk_f32 v119, v119, 0x3e0293ee, v253
    v_exp_f32 v117, v117
    v_cvt_pk_bf16_f32 v105, v114, v115
    v_fmamk_f32 v120, v120, 0x3e0293ee, v254
    v_exp_f32 v118, v118
    v_fmamk_f32 v121, v121, 0x3e0293ee, v254
    v_exp_f32 v119, v119
    v_cvt_pk_bf16_f32 v106, v116, v117
    v_fmamk_f32 v122, v122, 0x3e0293ee, v254
    v_exp_f32 v120, v120
    v_fmamk_f32 v123, v123, 0x3e0293ee, v254
    v_exp_f32 v121, v121
    v_cvt_pk_bf16_f32 v107, v118, v119
    v_fmamk_f32 v124, v124, 0x3e0293ee, v254
    v_exp_f32 v122, v122
    v_fmamk_f32 v125, v125, 0x3e0293ee, v254
    v_exp_f32 v123, v123
    v_cvt_pk_bf16_f32 v108, v120, v121
    v_fmamk_f32 v126, v126, 0x3e0293ee, v254
    v_exp_f32 v124, v124
    v_mfma_f32_16x16x32_bf16 v[164:167], v[232:235], v[140:143], v[164:167]
    ds_read_b64_tr_b16 v[248:249], v26 offset:24576
    ds_read_b64_tr_b16 v[250:251], v26 offset:28672
    v_fmamk_f32 v127, v127, 0x3e0293ee, v254
    v_exp_f32 v125, v125
    v_cvt_pk_bf16_f32 v109, v122, v123
    v_exp_f32 v126, v126
    v_exp_f32 v127, v127
    v_cvt_pk_bf16_f32 v110, v124, v125
    v_cvt_pk_bf16_f32 v111, v126, v127
    v_mfma_f32_16x16x32_bf16 v[12:15], v[8:11], v[128:131], v[12:15]
    v_mfma_f32_16x16x32_bf16 v[12:15], v[8:11], v[136:139], v[12:15]
    v_mfma_f32_16x16x32_bf16 v[16:19], v[8:11], v[132:135], v[16:19]
    ds_read_b64_tr_b16 v[224:225], v27 offset:16384
    ds_read_b64_tr_b16 v[226:227], v27 offset:20480
    v_mfma_f32_16x16x32_bf16 v[16:19], v[8:11], v[140:143], v[16:19]
    ds_read_b64_tr_b16 v[228:229], v27 offset:24576
    ds_read_b64_tr_b16 v[230:231], v27 offset:28672
    s_waitcnt lgkmcnt(8)
    v_mfma_f32_16x16x32_bf16 v[168:171], v[236:239], v[128:131], v[168:171]
    v_mfma_f32_16x16x32_bf16 v[168:171], v[240:243], v[136:139], v[168:171]
    v_mfma_f32_16x16x32_bf16 v[172:175], v[236:239], v[132:135], v[172:175]
    ds_read_b64_tr_b16 v[232:233], v28 offset:16384
    ds_read_b64_tr_b16 v[234:235], v28 offset:20480
    v_mfma_f32_16x16x32_bf16 v[172:175], v[240:243], v[140:143], v[172:175]
    ds_read_b64_tr_b16 v[236:237], v28 offset:24576
    ds_read_b64_tr_b16 v[238:239], v28 offset:28672
    s_waitcnt lgkmcnt(8)
    v_mfma_f32_16x16x32_bf16 v[176:179], v[244:247], v[128:131], v[176:179]
    v_mfma_f32_16x16x32_bf16 v[176:179], v[248:251], v[136:139], v[176:179]
    v_mfma_f32_16x16x32_bf16 v[180:183], v[244:247], v[132:135], v[180:183]
    ds_read_b64_tr_b16 v[240:241], v29 offset:16384
    ds_read_b64_tr_b16 v[242:243], v29 offset:20480
    v_mfma_f32_16x16x32_bf16 v[180:183], v[248:251], v[140:143], v[180:183]
    ds_read_b64_tr_b16 v[244:245], v29 offset:24576
    ds_read_b64_tr_b16 v[246:247], v29 offset:28672
    s_waitcnt lgkmcnt(8)
    v_mfma_f32_16x16x32_bf16 v[184:187], v[224:227], v[128:131], v[184:187]
    v_mfma_f32_16x16x32_bf16 v[184:187], v[228:231], v[136:139], v[184:187]
    v_mfma_f32_16x16x32_bf16 v[188:191], v[224:227], v[132:135], v[188:191]
    ds_read_b64_tr_b16 v[248:249], v30 offset:16384
    ds_read_b64_tr_b16 v[250:251], v30 offset:20480
    v_mfma_f32_16x16x32_bf16 v[188:191], v[228:231], v[140:143], v[188:191]
    ds_read_b64_tr_b16 v[224:225], v30 offset:24576
    ds_read_b64_tr_b16 v[226:227], v30 offset:28672
    s_waitcnt lgkmcnt(8)
    v_mfma_f32_16x16x32_bf16 v[192:195], v[232:235], v[128:131], v[192:195]
    v_mfma_f32_16x16x32_bf16 v[192:195], v[236:239], v[136:139], v[192:195]
    v_mfma_f32_16x16x32_bf16 v[196:199], v[232:235], v[132:135], v[196:199]
    ds_read_b64_tr_b16 v[228:229], v31 offset:16384
    ds_read_b64_tr_b16 v[230:231], v31 offset:20480
    v_mfma_f32_16x16x32_bf16 v[196:199], v[236:239], v[140:143], v[196:199]
    ds_read_b64_tr_b16 v[232:233], v31 offset:24576
    ds_read_b64_tr_b16 v[234:235], v31 offset:28672
    s_waitcnt lgkmcnt(8)
    v_mfma_f32_16x16x32_bf16 v[200:203], v[240:243], v[128:131], v[200:203]
    v_mfma_f32_16x16x32_bf16 v[200:203], v[244:247], v[136:139], v[200:203]
    v_mfma_f32_16x16x32_bf16 v[204:207], v[240:243], v[132:135], v[204:207]
    s_barrier
    ds_read_b128 v[236:239], v20 offset:49152
    s_add_u32 m0, s30, 114688
    s_add_u32 s31, s28, 49152
    buffer_load_dwordx4 v3, s[20:23], s31 offen offset:0 nt lds
    v_mfma_f32_16x16x32_bf16 v[204:207], v[244:247], v[140:143], v[204:207]
    ds_read_b128 v[240:243], v21 offset:49152
    s_waitcnt lgkmcnt(6)
    v_mfma_f32_16x16x32_bf16 v[208:211], v[248:251], v[128:131], v[208:211]
    ds_read_b128 v[244:247], v22 offset:49152
    v_mfma_f32_16x16x32_bf16 v[208:211], v[224:227], v[136:139], v[208:211]
    v_mfma_f32_16x16x32_bf16 v[212:215], v[248:251], v[132:135], v[212:215]
    ds_read_b128 v[248:251], v23 offset:49152
    v_mfma_f32_16x16x32_bf16 v[212:215], v[224:227], v[140:143], v[212:215]
    s_waitcnt lgkmcnt(4)
    v_mfma_f32_16x16x32_bf16 v[216:219], v[228:231], v[128:131], v[216:219]
    v_mfma_f32_16x16x32_bf16 v[216:219], v[232:235], v[136:139], v[216:219]
    v_mfma_f32_16x16x32_bf16 v[220:223], v[228:231], v[132:135], v[220:223]
    ds_read_b128 v[224:227], v20 offset:53248
    s_add_u32 m0, s30, 122880
    s_add_u32 s31, s28, 57344
    buffer_load_dwordx4 v3, s[20:23], s31 offen offset:0 nt lds
    v_mfma_f32_16x16x32_bf16 v[220:223], v[232:235], v[140:143], v[220:223]
    ds_read_b128 v[228:231], v21 offset:53248
    s_waitcnt lgkmcnt(4)
    v_mfma_f32_16x16x32_bf16 v[128:131], v[236:239], v[32:35], 0
    ds_read_b128 v[232:235], v22 offset:53248
    v_mfma_f32_16x16x32_bf16 v[128:131], v[240:243], v[40:43], v[128:131]
    s_waitcnt lgkmcnt(3)
    v_mfma_f32_16x16x32_bf16 v[128:131], v[244:247], v[48:51], v[128:131]
    v_mfma_f32_16x16x32_bf16 v[128:131], v[248:251], v[56:59], v[128:131]
    v_mfma_f32_16x16x32_bf16 v[136:139], v[236:239], v[36:39], 0
    ds_read_b128 v[236:239], v23 offset:53248
    v_mfma_f32_16x16x32_bf16 v[136:139], v[240:243], v[44:47], v[136:139]
    v_mfma_f32_16x16x32_bf16 v[136:139], v[244:247], v[52:55], v[136:139]
    ds_read_b128 v[240:243], v20 offset:57344
    s_add_u32 m0, s30, 0
    s_add_u32 s31, s29, 0
    buffer_load_dwordx4 v2, s[16:19], s31 offen offset:0 nt lds
    v_mfma_f32_16x16x32_bf16 v[136:139], v[248:251], v[60:63], v[136:139]
    ds_read_b128 v[244:247], v21 offset:57344
    s_waitcnt lgkmcnt(4)
    v_mfma_f32_16x16x32_bf16 v[132:135], v[224:227], v[32:35], 0
    ds_read_b128 v[248:251], v22 offset:57344
    v_mfma_f32_16x16x32_bf16 v[132:135], v[228:231], v[40:43], v[132:135]
    s_waitcnt lgkmcnt(3)
    v_mfma_f32_16x16x32_bf16 v[132:135], v[232:235], v[48:51], v[132:135]
    v_mfma_f32_16x16x32_bf16 v[132:135], v[236:239], v[56:59], v[132:135]
    v_mfma_f32_16x16x32_bf16 v[140:143], v[224:227], v[36:39], 0
    ds_read_b128 v[224:227], v23 offset:57344
    v_mfma_f32_16x16x32_bf16 v[140:143], v[228:231], v[44:47], v[140:143]
    v_mfma_f32_16x16x32_bf16 v[140:143], v[232:235], v[52:55], v[140:143]
    ds_read_b128 v[228:231], v20 offset:61440
    s_add_u32 m0, s30, 8192
    s_add_u32 s31, s29, 8192
    buffer_load_dwordx4 v2, s[16:19], s31 offen offset:0 nt lds
    v_mfma_f32_16x16x32_bf16 v[140:143], v[236:239], v[60:63], v[140:143]
    ds_read_b128 v[232:235], v21 offset:61440
    s_waitcnt lgkmcnt(4)
    v_mfma_f32_16x16x32_bf16 v[144:147], v[240:243], v[32:35], 0
    ds_read_b128 v[236:239], v22 offset:61440
    v_mfma_f32_16x16x32_bf16 v[144:147], v[244:247], v[40:43], v[144:147]
    s_waitcnt lgkmcnt(3)
    v_mfma_f32_16x16x32_bf16 v[144:147], v[248:251], v[48:51], v[144:147]
    v_fmamk_f32 v128, v128, 0x3e0293ee, v253
    v_fmamk_f32 v129, v129, 0x3e0293ee, v253
    v_fmamk_f32 v130, v130, 0x3e0293ee, v253
    v_exp_f32 v128, v128
    v_fmamk_f32 v131, v131, 0x3e0293ee, v253
    v_exp_f32 v129, v129
    v_fmamk_f32 v132, v132, 0x3e0293ee, v253
    v_exp_f32 v130, v130
    v_fmamk_f32 v133, v133, 0x3e0293ee, v253
    v_exp_f32 v131, v131
    v_cvt_pk_bf16_f32 v128, v128, v129
    v_fmamk_f32 v134, v134, 0x3e0293ee, v253
    v_exp_f32 v132, v132
    v_fmamk_f32 v135, v135, 0x3e0293ee, v253
    v_exp_f32 v133, v133
    v_cvt_pk_bf16_f32 v129, v130, v131
    v_fmamk_f32 v136, v136, 0x3e0293ee, v254
    v_exp_f32 v134, v134
    v_fmamk_f32 v137, v137, 0x3e0293ee, v254
    v_exp_f32 v135, v135
    v_cvt_pk_bf16_f32 v130, v132, v133
    v_fmamk_f32 v138, v138, 0x3e0293ee, v254
    v_exp_f32 v136, v136
    v_fmamk_f32 v139, v139, 0x3e0293ee, v254
    v_exp_f32 v137, v137
    v_cvt_pk_bf16_f32 v131, v134, v135
    v_fmamk_f32 v140, v140, 0x3e0293ee, v254
    v_exp_f32 v138, v138
    v_fmamk_f32 v141, v141, 0x3e0293ee, v254
    v_exp_f32 v139, v139
    v_cvt_pk_bf16_f32 v132, v136, v137
    v_fmamk_f32 v142, v142, 0x3e0293ee, v254
    v_exp_f32 v140, v140
    v_fmamk_f32 v143, v143, 0x3e0293ee, v254
    v_exp_f32 v141, v141
    v_cvt_pk_bf16_f32 v133, v138, v139
    v_mfma_f32_16x16x32_bf16 v[144:147], v[224:227], v[56:59], v[144:147]
    v_mfma_f32_16x16x32_bf16 v[152:155], v[240:243], v[36:39], 0
    ds_read_b128 v[240:243], v23 offset:61440
    v_mfma_f32_16x16x32_bf16 v[152:155], v[244:247], v[44:47], v[152:155]
    v_mfma_f32_16x16x32_bf16 v[152:155], v[248:251], v[52:55], v[152:155]
    s_waitcnt vmcnt(6)
    s_barrier
    ds_read_b64_tr_b16 v[244:245], v24 offset:32768
    ds_read_b64_tr_b16 v[246:247], v24 offset:36864
    s_add_u32 m0, s30, 16384
    s_add_u32 s31, s29, 16384
    buffer_load_dwordx4 v2, s[16:19], s31 offen offset:0 nt lds
    v_mfma_f32_16x16x32_bf16 v[152:155], v[224:227], v[60:63], v[152:155]
    ds_read_b64_tr_b16 v[248:249], v24 offset:40960
    ds_read_b64_tr_b16 v[250:251], v24 offset:45056
    s_waitcnt lgkmcnt(6)
    v_mfma_f32_16x16x32_bf16 v[148:151], v[228:231], v[32:35], 0
    v_mfma_f32_16x16x32_bf16 v[148:151], v[232:235], v[40:43], v[148:151]
    s_waitcnt lgkmcnt(4)
    v_mfma_f32_16x16x32_bf16 v[148:151], v[236:239], v[48:51], v[148:151]
    v_mfma_f32_16x16x32_bf16 v[148:151], v[240:243], v[56:59], v[148:151]
    s_add_u32 m0, s30, 24576
    s_add_u32 s31, s29, 24576
    buffer_load_dwordx4 v2, s[16:19], s31 offen offset:0 nt lds
    v_mfma_f32_16x16x32_bf16 v[156:159], v[228:231], v[36:39], 0
    v_mfma_f32_16x16x32_bf16 v[156:159], v[232:235], v[44:47], v[156:159]
    v_mfma_f32_16x16x32_bf16 v[156:159], v[236:239], v[52:55], v[156:159]
    ds_read_b64_tr_b16 v[224:225], v25 offset:32768
    ds_read_b64_tr_b16 v[226:227], v25 offset:36864
    v_mfma_f32_16x16x32_bf16 v[156:159], v[240:243], v[60:63], v[156:159]
    ds_read_b64_tr_b16 v[228:229], v25 offset:40960
    ds_read_b64_tr_b16 v[230:231], v25 offset:45056
    s_waitcnt lgkmcnt(4)
    v_mfma_f32_16x16x32_bf16 v[160:163], v[244:247], v[96:99], v[160:163]
    s_add_u32 m0, s30, 65536
    s_add_u32 s31, s29, 0
    buffer_load_dwordx4 v3, s[20:23], s31 offen offset:0 nt lds
    v_mfma_f32_16x16x32_bf16 v[160:163], v[248:251], v[104:107], v[160:163]
    v_mfma_f32_16x16x32_bf16 v[164:167], v[244:247], v[100:103], v[164:167]
    ds_read_b64_tr_b16 v[232:233], v26 offset:32768
    ds_read_b64_tr_b16 v[234:235], v26 offset:36864
    v_fmamk_f32 v144, v144, 0x3e0293ee, v253
    v_exp_f32 v142, v142
    v_fmamk_f32 v145, v145, 0x3e0293ee, v253
    v_exp_f32 v143, v143
    v_cvt_pk_bf16_f32 v134, v140, v141
    v_fmamk_f32 v146, v146, 0x3e0293ee, v253
    v_exp_f32 v144, v144
    v_fmamk_f32 v147, v147, 0x3e0293ee, v253
    v_exp_f32 v145, v145
    v_cvt_pk_bf16_f32 v135, v142, v143
    v_fmamk_f32 v148, v148, 0x3e0293ee, v253
    v_exp_f32 v146, v146
    v_fmamk_f32 v149, v149, 0x3e0293ee, v253
    v_exp_f32 v147, v147
    v_cvt_pk_bf16_f32 v136, v144, v145
    v_fmamk_f32 v150, v150, 0x3e0293ee, v253
    v_exp_f32 v148, v148
    v_fmamk_f32 v151, v151, 0x3e0293ee, v253
    v_exp_f32 v149, v149
    v_cvt_pk_bf16_f32 v137, v146, v147
    v_fmamk_f32 v152, v152, 0x3e0293ee, v254
    v_exp_f32 v150, v150
    v_fmamk_f32 v153, v153, 0x3e0293ee, v254
    v_exp_f32 v151, v151
    v_cvt_pk_bf16_f32 v138, v148, v149
    v_fmamk_f32 v154, v154, 0x3e0293ee, v254
    v_exp_f32 v152, v152
    v_fmamk_f32 v155, v155, 0x3e0293ee, v254
    v_exp_f32 v153, v153
    v_cvt_pk_bf16_f32 v139, v150, v151
    v_fmamk_f32 v156, v156, 0x3e0293ee, v254
    v_exp_f32 v154, v154
    v_fmamk_f32 v157, v157, 0x3e0293ee, v254
    v_exp_f32 v155, v155
    v_cvt_pk_bf16_f32 v140, v152, v153
    v_fmamk_f32 v158, v158, 0x3e0293ee, v254
    v_exp_f32 v156, v156
    v_mfma_f32_16x16x32_bf16 v[164:167], v[248:251], v[108:111], v[164:167]
    ds_read_b64_tr_b16 v[236:237], v26 offset:40960
    ds_read_b64_tr_b16 v[238:239], v26 offset:45056
    v_fmamk_f32 v159, v159, 0x3e0293ee, v254
    v_exp_f32 v157, v157
    v_cvt_pk_bf16_f32 v141, v154, v155
    v_exp_f32 v158, v158
    v_exp_f32 v159, v159
    v_cvt_pk_bf16_f32 v142, v156, v157
    v_cvt_pk_bf16_f32 v143, v158, v159
    v_mfma_f32_16x16x32_bf16 v[12:15], v[8:11], v[96:99], v[12:15]
    v_mfma_f32_16x16x32_bf16 v[12:15], v[8:11], v[104:107], v[12:15]
    s_add_u32 m0, s30, 73728
    s_add_u32 s31, s29, 8192
    buffer_load_dwordx4 v3, s[20:23], s31 offen offset:0 nt lds
    v_mfma_f32_16x16x32_bf16 v[16:19], v[8:11], v[100:103], v[16:19]
    ds_read_b64_tr_b16 v[240:241], v27 offset:32768
    ds_read_b64_tr_b16 v[242:243], v27 offset:36864
    v_mfma_f32_16x16x32_bf16 v[16:19], v[8:11], v[108:111], v[16:19]
    ds_read_b64_tr_b16 v[244:245], v27 offset:40960
    ds_read_b64_tr_b16 v[246:247], v27 offset:45056
    s_waitcnt lgkmcnt(8)
    v_mfma_f32_16x16x32_bf16 v[168:171], v[224:227], v[96:99], v[168:171]
    v_mfma_f32_16x16x32_bf16 v[168:171], v[228:231], v[104:107], v[168:171]
    v_mfma_f32_16x16x32_bf16 v[172:175], v[224:227], v[100:103], v[172:175]
    s_waitcnt vmcnt(6)
    s_barrier
    ds_read_b64_tr_b16 v[248:249], v24 offset:49152
    ds_read_b64_tr_b16 v[250:251], v24 offset:53248
    v_mfma_f32_16x16x32_bf16 v[172:175], v[228:231], v[108:111], v[172:175]
    ds_read_b64_tr_b16 v[224:225], v24 offset:57344
    ds_read_b64_tr_b16 v[226:227], v24 offset:61440
    s_waitcnt lgkmcnt(8)
    v_mfma_f32_16x16x32_bf16 v[176:179], v[232:235], v[96:99], v[176:179]
    v_mfma_f32_16x16x32_bf16 v[176:179], v[236:239], v[104:107], v[176:179]
    v_mfma_f32_16x16x32_bf16 v[180:183], v[232:235], v[100:103], v[180:183]
    v_mfma_f32_16x16x32_bf16 v[180:183], v[236:239], v[108:111], v[180:183]
    s_waitcnt lgkmcnt(4)
    v_mfma_f32_16x16x32_bf16 v[184:187], v[240:243], v[96:99], v[184:187]
    v_mfma_f32_16x16x32_bf16 v[184:187], v[244:247], v[104:107], v[184:187]
    v_mfma_f32_16x16x32_bf16 v[188:191], v[240:243], v[100:103], v[188:191]
    ds_read_b64_tr_b16 v[228:229], v25 offset:49152
    ds_read_b64_tr_b16 v[230:231], v25 offset:53248
    v_mfma_f32_16x16x32_bf16 v[188:191], v[244:247], v[108:111], v[188:191]
    ds_read_b64_tr_b16 v[232:233], v25 offset:57344
    ds_read_b64_tr_b16 v[234:235], v25 offset:61440
    s_waitcnt lgkmcnt(4)
    v_mfma_f32_16x16x32_bf16 v[160:163], v[248:251], v[128:131], v[160:163]
    v_mfma_f32_16x16x32_bf16 v[160:163], v[224:227], v[136:139], v[160:163]
    v_mfma_f32_16x16x32_bf16 v[164:167], v[248:251], v[132:135], v[164:167]
    ds_read_b64_tr_b16 v[236:237], v26 offset:49152
    ds_read_b64_tr_b16 v[238:239], v26 offset:53248
    v_mfma_f32_16x16x32_bf16 v[164:167], v[224:227], v[140:143], v[164:167]
    ds_read_b64_tr_b16 v[240:241], v26 offset:57344
    ds_read_b64_tr_b16 v[242:243], v26 offset:61440
    v_mfma_f32_16x16x32_bf16 v[12:15], v[8:11], v[128:131], v[12:15]
    v_mfma_f32_16x16x32_bf16 v[12:15], v[8:11], v[136:139], v[12:15]
    v_mfma_f32_16x16x32_bf16 v[16:19], v[8:11], v[132:135], v[16:19]
    ds_read_b64_tr_b16 v[244:245], v27 offset:49152
    ds_read_b64_tr_b16 v[246:247], v27 offset:53248
    v_mfma_f32_16x16x32_bf16 v[16:19], v[8:11], v[140:143], v[16:19]
    ds_read_b64_tr_b16 v[248:249], v27 offset:57344
    ds_read_b64_tr_b16 v[250:251], v27 offset:61440
    s_waitcnt lgkmcnt(8)
    v_mfma_f32_16x16x32_bf16 v[168:171], v[228:231], v[128:131], v[168:171]
    v_mfma_f32_16x16x32_bf16 v[168:171], v[232:235], v[136:139], v[168:171]
    v_mfma_f32_16x16x32_bf16 v[172:175], v[228:231], v[132:135], v[172:175]
    ds_read_b64_tr_b16 v[224:225], v28 offset:32768
    ds_read_b64_tr_b16 v[226:227], v28 offset:36864
    v_max_f32 v14, v12, v16
    v_rcp_f32 v13, v12
    v_rcp_f32 v17, v16
    v_cmp_ngt_f32 vcc, s44, v14
    v_mul_f32 v160, v13, v160
    v_mul_f32 v161, v13, v161
    v_mul_f32 v162, v13, v162
    v_mul_f32 v163, v13, v163
    v_cvt_pk_bf16_f32 v32, v160, v161
    v_mul_f32 v164, v17, v164
    v_mul_f32 v165, v17, v165
    v_cvt_pk_bf16_f32 v33, v162, v163
    v_mul_f32 v166, v17, v166
    v_mul_f32 v167, v17, v167
    v_cvt_pk_bf16_f32 v34, v164, v165
    v_cvt_pk_bf16_f32 v35, v166, v167
    s_cmp_lg_u64 vcc, 0
    s_cselect_b32 s36, 1, 0
    s_or_b32 s34, s34, s36
    v_mfma_f32_16x16x32_bf16 v[172:175], v[232:235], v[140:143], v[172:175]
    ds_read_b64_tr_b16 v[228:229], v28 offset:40960
    ds_read_b64_tr_b16 v[230:231], v28 offset:45056
    s_waitcnt lgkmcnt(8)
    v_mfma_f32_16x16x32_bf16 v[176:179], v[236:239], v[128:131], v[176:179]
    ds_read_b64_tr_b16 v[232:233], v28 offset:49152
    ds_read_b64_tr_b16 v[234:235], v28 offset:53248
    v_mfma_f32_16x16x32_bf16 v[176:179], v[240:243], v[136:139], v[176:179]
    v_mfma_f32_16x16x32_bf16 v[180:183], v[236:239], v[132:135], v[180:183]
    ds_read_b64_tr_b16 v[236:237], v28 offset:57344
    ds_read_b64_tr_b16 v[238:239], v28 offset:61440
    v_mul_f32 v168, v13, v168
    v_mul_f32 v169, v13, v169
    v_mul_f32 v170, v13, v170
    v_mul_f32 v171, v13, v171
    v_cvt_pk_bf16_f32 v36, v168, v169
    v_mul_f32 v172, v17, v172
    v_mul_f32 v173, v17, v173
    v_cvt_pk_bf16_f32 v37, v170, v171
    v_mul_f32 v174, v17, v174
    v_mul_f32 v175, v17, v175
    v_cvt_pk_bf16_f32 v38, v172, v173
    v_cvt_pk_bf16_f32 v39, v174, v175
    v_mfma_f32_16x16x32_bf16 v[180:183], v[240:243], v[140:143], v[180:183]
    s_waitcnt lgkmcnt(8)
    v_mfma_f32_16x16x32_bf16 v[184:187], v[244:247], v[128:131], v[184:187]
    v_mfma_f32_16x16x32_bf16 v[184:187], v[248:251], v[136:139], v[184:187]
    v_mfma_f32_16x16x32_bf16 v[188:191], v[244:247], v[132:135], v[188:191]
    ds_read_b64_tr_b16 v[240:241], v29 offset:32768
    ds_read_b64_tr_b16 v[242:243], v29 offset:36864
    v_mul_f32 v176, v13, v176
    v_mul_f32 v177, v13, v177
    v_mul_f32 v178, v13, v178
    v_mul_f32 v179, v13, v179
    v_cvt_pk_bf16_f32 v40, v176, v177
    v_mul_f32 v180, v17, v180
    v_mul_f32 v181, v17, v181
    v_cvt_pk_bf16_f32 v41, v178, v179
    v_mul_f32 v182, v17, v182
    v_mul_f32 v183, v17, v183
    v_cvt_pk_bf16_f32 v42, v180, v181
    v_cvt_pk_bf16_f32 v43, v182, v183
    v_mfma_f32_16x16x32_bf16 v[188:191], v[248:251], v[140:143], v[188:191]
    ds_read_b64_tr_b16 v[244:245], v29 offset:40960
    ds_read_b64_tr_b16 v[246:247], v29 offset:45056
    s_waitcnt lgkmcnt(8)
    v_mfma_f32_16x16x32_bf16 v[192:195], v[224:227], v[96:99], v[192:195]
    ds_read_b64_tr_b16 v[248:249], v29 offset:49152
    ds_read_b64_tr_b16 v[250:251], v29 offset:53248
    v_mfma_f32_16x16x32_bf16 v[192:195], v[228:231], v[104:107], v[192:195]
    s_waitcnt lgkmcnt(6)
    v_mfma_f32_16x16x32_bf16 v[192:195], v[232:235], v[128:131], v[192:195]
    v_mul_f32 v184, v13, v184
    v_mul_f32 v185, v13, v185
    v_mul_f32 v186, v13, v186
    v_mul_f32 v187, v13, v187
    v_cvt_pk_bf16_f32 v44, v184, v185
    v_mul_f32 v188, v17, v188
    v_mul_f32 v189, v17, v189
    v_cvt_pk_bf16_f32 v45, v186, v187
    v_mul_f32 v190, v17, v190
    v_mul_f32 v191, v17, v191
    v_cvt_pk_bf16_f32 v46, v188, v189
    v_cvt_pk_bf16_f32 v47, v190, v191
    v_mfma_f32_16x16x32_bf16 v[192:195], v[236:239], v[136:139], v[192:195]
    v_mfma_f32_16x16x32_bf16 v[196:199], v[224:227], v[100:103], v[196:199]
    ds_read_b64_tr_b16 v[224:225], v29 offset:57344
    ds_read_b64_tr_b16 v[226:227], v29 offset:61440
    v_mfma_f32_16x16x32_bf16 v[196:199], v[228:231], v[108:111], v[196:199]
    v_mfma_f32_16x16x32_bf16 v[196:199], v[232:235], v[132:135], v[196:199]
    ds_read_b64_tr_b16 v[228:229], v30 offset:32768
    ds_read_b64_tr_b16 v[230:231], v30 offset:36864
    v_mfma_f32_16x16x32_bf16 v[196:199], v[236:239], v[140:143], v[196:199]
    ds_read_b64_tr_b16 v[232:233], v30 offset:40960
    ds_read_b64_tr_b16 v[234:235], v30 offset:45056
    s_waitcnt lgkmcnt(8)
    v_mfma_f32_16x16x32_bf16 v[200:203], v[240:243], v[96:99], v[200:203]
    ds_read_b64_tr_b16 v[236:237], v30 offset:49152
    ds_read_b64_tr_b16 v[238:239], v30 offset:53248
    v_mfma_f32_16x16x32_bf16 v[200:203], v[244:247], v[104:107], v[200:203]
    s_waitcnt lgkmcnt(6)
    v_mfma_f32_16x16x32_bf16 v[200:203], v[248:251], v[128:131], v[200:203]
    v_mul_f32 v192, v13, v192
    v_mul_f32 v193, v13, v193
    v_mul_f32 v194, v13, v194
    v_mul_f32 v195, v13, v195
    v_cvt_pk_bf16_f32 v48, v192, v193
    v_mul_f32 v196, v17, v196
    v_mul_f32 v197, v17, v197
    v_cvt_pk_bf16_f32 v49, v194, v195
    v_mul_f32 v198, v17, v198
    v_mul_f32 v199, v17, v199
    v_cvt_pk_bf16_f32 v50, v196, v197
    v_cvt_pk_bf16_f32 v51, v198, v199
    v_mfma_f32_16x16x32_bf16 v[200:203], v[224:227], v[136:139], v[200:203]
    v_mfma_f32_16x16x32_bf16 v[204:207], v[240:243], v[100:103], v[204:207]
    ds_read_b64_tr_b16 v[240:241], v30 offset:57344
    ds_read_b64_tr_b16 v[242:243], v30 offset:61440
    v_mfma_f32_16x16x32_bf16 v[204:207], v[244:247], v[108:111], v[204:207]
    v_mfma_f32_16x16x32_bf16 v[204:207], v[248:251], v[132:135], v[204:207]
    ds_read_b64_tr_b16 v[244:245], v31 offset:32768
    ds_read_b64_tr_b16 v[246:247], v31 offset:36864
    v_mfma_f32_16x16x32_bf16 v[204:207], v[224:227], v[140:143], v[204:207]
    ds_read_b64_tr_b16 v[248:249], v31 offset:40960
    ds_read_b64_tr_b16 v[250:251], v31 offset:45056
    s_waitcnt lgkmcnt(8)
    v_mfma_f32_16x16x32_bf16 v[208:211], v[228:231], v[96:99], v[208:211]
    ds_read_b64_tr_b16 v[224:225], v31 offset:49152
    ds_read_b64_tr_b16 v[226:227], v31 offset:53248
    s_add_u32 m0, s30, 32768
    s_add_u32 s31, s29, 32768
    buffer_load_dwordx4 v2, s[16:19], s31 offen offset:0 nt lds
    v_xor_b32 v92, 64, v4
    ds_read_b128 v[80:83], v4 offset:32768
    ds_read_b128 v[84:87], v4 offset:34816
    ds_read_b128 v[88:91], v92 offset:32768
    ds_read_b128 v[92:95], v92 offset:34816
    v_mfma_f32_16x16x32_bf16 v[208:211], v[232:235], v[104:107], v[208:211]
    s_waitcnt lgkmcnt(10)
    v_mfma_f32_16x16x32_bf16 v[208:211], v[236:239], v[128:131], v[208:211]
    v_mul_f32 v200, v13, v200
    v_mul_f32 v201, v13, v201
    v_mul_f32 v202, v13, v202
    v_mul_f32 v203, v13, v203
    v_cvt_pk_bf16_f32 v52, v200, v201
    v_mul_f32 v204, v17, v204
    v_mul_f32 v205, v17, v205
    v_cvt_pk_bf16_f32 v53, v202, v203
    v_mul_f32 v206, v17, v206
    v_mul_f32 v207, v17, v207
    v_cvt_pk_bf16_f32 v54, v204, v205
    v_cvt_pk_bf16_f32 v55, v206, v207
    v_mfma_f32_16x16x32_bf16 v[208:211], v[240:243], v[136:139], v[208:211]
    s_add_u32 m0, s30, 40960
    s_add_u32 s31, s29, 40960
    buffer_load_dwordx4 v2, s[16:19], s31 offen offset:0 nt lds
    v_mfma_f32_16x16x32_bf16 v[212:215], v[228:231], v[100:103], v[212:215]
    ds_read_b64_tr_b16 v[228:229], v31 offset:57344
    ds_read_b64_tr_b16 v[230:231], v31 offset:61440
    v_mfma_f32_16x16x32_bf16 v[212:215], v[232:235], v[108:111], v[212:215]
    v_mfma_f32_16x16x32_bf16 v[212:215], v[236:239], v[132:135], v[212:215]
    s_waitcnt vmcnt(6)
    s_barrier
    ds_read_b128 v[232:235], v20 offset:0
    s_add_u32 m0, s30, 81920
    s_add_u32 s31, s29, 16384
    buffer_load_dwordx4 v3, s[20:23], s31 offen offset:0 nt lds
    v_mfma_f32_16x16x32_bf16 v[212:215], v[240:243], v[140:143], v[212:215]
    ds_read_b128 v[236:239], v21 offset:0
    s_waitcnt lgkmcnt(10)
    v_mfma_f32_16x16x32_bf16 v[216:219], v[244:247], v[96:99], v[216:219]
    ds_read_b128 v[240:243], v22 offset:0
    v_mfma_f32_16x16x32_bf16 v[216:219], v[248:251], v[104:107], v[216:219]
    s_waitcnt lgkmcnt(3)
    v_mfma_f32_16x16x32_bf16 v[216:219], v[224:227], v[128:131], v[216:219]
    v_mul_f32 v208, v13, v208
    v_mul_f32 v209, v13, v209
    v_mul_f32 v210, v13, v210
    v_mul_f32 v211, v13, v211
    v_cvt_pk_bf16_f32 v56, v208, v209
    v_mul_f32 v212, v17, v212
    v_mul_f32 v213, v17, v213
    v_cvt_pk_bf16_f32 v57, v210, v211
    v_mul_f32 v214, v17, v214
    v_mul_f32 v215, v17, v215
    v_cvt_pk_bf16_f32 v58, v212, v213
    v_cvt_pk_bf16_f32 v59, v214, v215
    v_mfma_f32_16x16x32_bf16 v[216:219], v[228:231], v[136:139], v[216:219]
    v_mfma_f32_16x16x32_bf16 v[220:223], v[244:247], v[100:103], v[220:223]
    ds_read_b128 v[244:247], v23 offset:0
    v_mfma_f32_16x16x32_bf16 v[220:223], v[248:251], v[108:111], v[220:223]
    v_mfma_f32_16x16x32_bf16 v[220:223], v[224:227], v[132:135], v[220:223]
    ds_read_b128 v[248:251], v20 offset:4096
    v_mfma_f32_16x16x32_bf16 v[220:223], v[228:231], v[140:143], v[220:223]
    ds_read_b128 v[224:227], v21 offset:4096
    s_waitcnt lgkmcnt(4)
    v_mfma_f32_16x16x32_bf16 v[96:99], v[232:235], v[64:67], 0
    ds_read_b128 v[228:231], v22 offset:4096
    v_mfma_f32_16x16x32_bf16 v[96:99], v[236:239], v[72:75], v[96:99]
    s_waitcnt lgkmcnt(3)
    v_mfma_f32_16x16x32_bf16 v[96:99], v[240:243], v[80:83], v[96:99]
    v_mul_f32 v216, v13, v216
    v_mul_f32 v217, v13, v217
    v_mul_f32 v218, v13, v218
    v_mfma_f32_16x16x32_bf16 v[96:99], v[244:247], v[88:91], v[96:99]
    v_mul_f32 v219, v13, v219
    v_cvt_pk_bf16_f32 v60, v216, v217
    v_mfma_f32_16x16x32_bf16 v[104:107], v[232:235], v[68:71], 0
    ds_read_b128 v[232:235], v23 offset:4096
    v_mul_f32 v220, v17, v220
    v_mul_f32 v221, v17, v221
    v_mfma_f32_16x16x32_bf16 v[104:107], v[236:239], v[76:79], v[104:107]
    v_cvt_pk_bf16_f32 v61, v218, v219
    v_mul_f32 v222, v17, v222
    v_mfma_f32_16x16x32_bf16 v[104:107], v[240:243], v[84:87], v[104:107]
    ds_read_b128 v[236:239], v20 offset:8192
    s_add_u32 m0, s30, 90112
    s_add_u32 s31, s29, 24576
    buffer_load_dwordx4 v3, s[20:23], s31 offen offset:0 nt lds
    v_mul_f32 v223, v17, v223
    v_cvt_pk_bf16_f32 v62, v220, v221
    v_mfma_f32_16x16x32_bf16 v[104:107], v[244:247], v[92:95], v[104:107]
    ds_read_b128 v[240:243], v21 offset:8192
    v_cvt_pk_bf16_f32 v63, v222, v223
    s_waitcnt lgkmcnt(4)
    v_mfma_f32_16x16x32_bf16 v[100:103], v[248:251], v[64:67], 0
    ds_read_b128 v[244:247], v22 offset:8192
    v_mfma_f32_16x16x32_bf16 v[100:103], v[224:227], v[72:75], v[100:103]
    s_waitcnt lgkmcnt(3)
    v_mfma_f32_16x16x32_bf16 v[100:103], v[228:231], v[80:83], v[100:103]
    v_mfma_f32_16x16x32_bf16 v[100:103], v[232:235], v[88:91], v[100:103]
    v_mfma_f32_16x16x32_bf16 v[108:111], v[248:251], v[68:71], 0
    ds_read_b128 v[248:251], v23 offset:8192
    v_mfma_f32_16x16x32_bf16 v[108:111], v[224:227], v[76:79], v[108:111]
    v_mfma_f32_16x16x32_bf16 v[108:111], v[228:231], v[84:87], v[108:111]
    ds_read_b128 v[224:227], v20 offset:12288
    v_mfma_f32_16x16x32_bf16 v[108:111], v[232:235], v[92:95], v[108:111]
    ds_read_b128 v[228:231], v21 offset:12288
    s_waitcnt lgkmcnt(4)
    v_mfma_f32_16x16x32_bf16 v[112:115], v[236:239], v[64:67], 0
    ds_read_b128 v[232:235], v22 offset:12288
    v_mfma_f32_16x16x32_bf16 v[112:115], v[240:243], v[72:75], v[112:115]
    s_waitcnt lgkmcnt(3)
    v_mfma_f32_16x16x32_bf16 v[112:115], v[244:247], v[80:83], v[112:115]
    v_max_f32 v0, v96, v97
    v_max_f32 v5, v104, v105
    v_max3_f32 v0, v0, v98, v99
    v_mfma_f32_16x16x32_bf16 v[112:115], v[248:251], v[88:91], v[112:115]
    v_max3_f32 v5, v5, v106, v107
    v_max3_f32 v0, v0, v100, v101
    v_mfma_f32_16x16x32_bf16 v[120:123], v[236:239], v[68:71], 0
    ds_read_b128 v[236:239], v23 offset:12288
    v_max3_f32 v5, v5, v108, v109
    v_max3_f32 v0, v0, v102, v103
    v_mfma_f32_16x16x32_bf16 v[120:123], v[240:243], v[76:79], v[120:123]
    v_max3_f32 v5, v5, v110, v111
    v_mfma_f32_16x16x32_bf16 v[120:123], v[244:247], v[84:87], v[120:123]
    s_waitcnt vmcnt(6)
    s_barrier
    ds_read_b128 v[240:243], v20 offset:16384
    s_add_u32 m0, s30, 49152
    s_add_u32 s31, s29, 49152
    buffer_load_dwordx4 v2, s[16:19], s31 offen offset:0 nt lds
    v_mfma_f32_16x16x32_bf16 v[120:123], v[248:251], v[92:95], v[120:123]
    ds_read_b128 v[244:247], v21 offset:16384
    s_waitcnt lgkmcnt(4)
    v_mfma_f32_16x16x32_bf16 v[116:119], v[224:227], v[64:67], 0
    ds_read_b128 v[248:251], v22 offset:16384
    v_mfma_f32_16x16x32_bf16 v[116:119], v[228:231], v[72:75], v[116:119]
    s_waitcnt lgkmcnt(3)
    v_mfma_f32_16x16x32_bf16 v[116:119], v[232:235], v[80:83], v[116:119]
    v_mfma_f32_16x16x32_bf16 v[116:119], v[236:239], v[88:91], v[116:119]
    v_mfma_f32_16x16x32_bf16 v[124:127], v[224:227], v[68:71], 0
    ds_read_b128 v[224:227], v23 offset:16384
    v_mfma_f32_16x16x32_bf16 v[124:127], v[228:231], v[76:79], v[124:127]
    v_mfma_f32_16x16x32_bf16 v[124:127], v[232:235], v[84:87], v[124:127]
    ds_read_b128 v[228:231], v20 offset:20480
    v_mfma_f32_16x16x32_bf16 v[124:127], v[236:239], v[92:95], v[124:127]
    ds_read_b128 v[232:235], v21 offset:20480
    s_waitcnt lgkmcnt(4)
    v_mfma_f32_16x16x32_bf16 v[128:131], v[240:243], v[64:67], 0
    ds_read_b128 v[236:239], v22 offset:20480
    v_mfma_f32_16x16x32_bf16 v[128:131], v[244:247], v[72:75], v[128:131]
    s_waitcnt lgkmcnt(3)
    v_mfma_f32_16x16x32_bf16 v[128:131], v[248:251], v[80:83], v[128:131]
    v_max3_f32 v0, v0, v112, v113
    v_max3_f32 v5, v5, v120, v121
    v_max3_f32 v0, v0, v114, v115
    v_max3_f32 v5, v5, v122, v123
    v_max3_f32 v0, v0, v116, v117
    v_mfma_f32_16x16x32_bf16 v[128:131], v[224:227], v[88:91], v[128:131]
    v_max3_f32 v5, v5, v124, v125
    v_max3_f32 v0, v0, v118, v119
    v_max3_f32 v5, v5, v126, v127
    s_nop 1
    v_permlane32_swap_b32 v0, v5
    v_mfma_f32_16x16x32_bf16 v[136:139], v[240:243], v[68:71], 0
    ds_read_b128 v[240:243], v23 offset:20480
    v_max_f32 v0, v0, v5
    v_mov_b32 v5, v0
    s_nop 1
    v_permlane16_swap_b32 v0, v5
    v_mfma_f32_16x16x32_bf16 v[136:139], v[244:247], v[76:79], v[136:139]
    v_max_f32 v0, v0, v5
    v_mul_f32 v253, s41, v0
    v_mul_f32 v254, s41, v0
    v_mfma_f32_16x16x32_bf16 v[136:139], v[248:251], v[84:87], v[136:139]
    ds_read_b128 v[244:247], v20 offset:24576
    s_add_u32 m0, s30, 57344
    s_add_u32 s31, s29, 57344
    buffer_load_dwordx4 v2, s[16:19], s31 offen offset:0 nt lds
    v_permlane32_swap_b32 v253, v254
    v_fmamk_f32 v96, v96, 0x3e0293ee, v253
    v_fmamk_f32 v97, v97, 0x3e0293ee, v253
    v_fmamk_f32 v98, v98, 0x3e0293ee, v253
    v_mfma_f32_16x16x32_bf16 v[136:139], v[224:227], v[92:95], v[136:139]
    ds_read_b128 v[248:251], v21 offset:24576
    v_exp_f32 v96, v96
    v_fmamk_f32 v99, v99, 0x3e0293ee, v253
    v_exp_f32 v97, v97
    s_waitcnt lgkmcnt(4)
    v_mfma_f32_16x16x32_bf16 v[132:135], v[228:231], v[64:67], 0
    ds_read_b128 v[224:227], v22 offset:24576
    v_fmamk_f32 v100, v100, 0x3e0293ee, v253
    v_exp_f32 v98, v98
    v_fmamk_f32 v101, v101, 0x3e0293ee, v253
    v_mfma_f32_16x16x32_bf16 v[132:135], v[232:235], v[72:75], v[132:135]
    v_exp_f32 v99, v99
    v_cvt_pk_bf16_f32 v96, v96, v97
    v_fmamk_f32 v102, v102, 0x3e0293ee, v253
    s_waitcnt lgkmcnt(3)
    v_mfma_f32_16x16x32_bf16 v[132:135], v[236:239], v[80:83], v[132:135]
    v_exp_f32 v100, v100
    v_fmamk_f32 v103, v103, 0x3e0293ee, v253
    v_mfma_f32_16x16x32_bf16 v[132:135], v[240:243], v[88:91], v[132:135]
    v_exp_f32 v101, v101
    v_cvt_pk_bf16_f32 v97, v98, v99
    v_fmamk_f32 v104, v104, 0x3e0293ee, v254
    v_exp_f32 v102, v102
    v_mfma_f32_16x16x32_bf16 v[140:143], v[228:231], v[68:71], 0
    ds_read_b128 v[228:231], v23 offset:24576
    v_fmamk_f32 v105, v105, 0x3e0293ee, v254
    v_exp_f32 v103, v103
    v_mfma_f32_16x16x32_bf16 v[140:143], v[232:235], v[76:79], v[140:143]
    v_cvt_pk_bf16_f32 v98, v100, v101
    v_fmamk_f32 v106, v106, 0x3e0293ee, v254
    v_exp_f32 v104, v104
    v_fmamk_f32 v107, v107, 0x3e0293ee, v254
    v_mfma_f32_16x16x32_bf16 v[140:143], v[236:239], v[84:87], v[140:143]
    ds_read_b128 v[232:235], v20 offset:28672
    v_exp_f32 v105, v105
    v_cvt_pk_bf16_f32 v99, v102, v103
    v_fmamk_f32 v108, v108, 0x3e0293ee, v254
    v_mfma_f32_16x16x32_bf16 v[140:143], v[240:243], v[92:95], v[140:143]
    ds_read_b128 v[236:239], v21 offset:28672
    v_exp_f32 v106, v106
    v_fmamk_f32 v109, v109, 0x3e0293ee, v254
    v_exp_f32 v107, v107
    s_waitcnt lgkmcnt(4)
    v_mfma_f32_16x16x32_bf16 v[144:147], v[244:247], v[64:67], 0
    ds_read_b128 v[240:243], v22 offset:28672
    v_cvt_pk_bf16_f32 v100, v104, v105
    v_fmamk_f32 v110, v110, 0x3e0293ee, v254
    v_exp_f32 v108, v108
    v_mfma_f32_16x16x32_bf16 v[144:147], v[248:251], v[72:75], v[144:147]
    v_fmamk_f32 v111, v111, 0x3e0293ee, v254
    v_exp_f32 v109, v109
    s_waitcnt lgkmcnt(3)
    v_mfma_f32_16x16x32_bf16 v[144:147], v[224:227], v[80:83], v[144:147]
    v_cvt_pk_bf16_f32 v101, v106, v107
    v_fmamk_f32 v112, v112, 0x3e0293ee, v253
    v_exp_f32 v110, v110
    v_fmamk_f32 v113, v113, 0x3e0293ee, v253
    v_mfma_f32_16x16x32_bf16 v[144:147], v[228:231], v[88:91], v[144:147]
    v_exp_f32 v111, v111
    v_cvt_pk_bf16_f32 v102, v108, v109
    v_fmamk_f32 v114, v114, 0x3e0293ee, v253
    v_mfma_f32_16x16x32_bf16 v[152:155], v[244:247], v[68:71], 0
    ds_read_b128 v[244:247], v23 offset:28672
    v_exp_f32 v112, v112
    v_fmamk_f32 v115, v115, 0x3e0293ee, v253
    v_exp_f32 v113, v113
    v_mfma_f32_16x16x32_bf16 v[152:155], v[248:251], v[76:79], v[152:155]
    v_cvt_pk_bf16_f32 v103, v110, v111
    v_fmamk_f32 v116, v116, 0x3e0293ee, v253
    v_exp_f32 v114, v114
    v_mfma_f32_16x16x32_bf16 v[152:155], v[224:227], v[84:87], v[152:155]
    s_waitcnt vmcnt(6)
    s_barrier
    ds_read_b64_tr_b16 v[248:249], v24 offset:0
    ds_read_b64_tr_b16 v[250:251], v24 offset:4096
    s_add_u32 m0, s30, 98304
    s_add_u32 s31, s29, 32768
    buffer_load_dwordx4 v3, s[20:23], s31 offen offset:0 nt lds
    v_fmamk_f32 v117, v117, 0x3e0293ee, v253
    v_exp_f32 v115, v115
    v_mfma_f32_16x16x32_bf16 v[152:155], v[228:231], v[92:95], v[152:155]
    ds_read_b64_tr_b16 v[224:225], v24 offset:8192
    ds_read_b64_tr_b16 v[226:227], v24 offset:12288
    v_cvt_pk_bf16_f32 v104, v112, v113
    v_fmamk_f32 v118, v118, 0x3e0293ee, v253
    v_exp_f32 v116, v116
    v_fmamk_f32 v119, v119, 0x3e0293ee, v253
    s_waitcnt lgkmcnt(6)
    v_mfma_f32_16x16x32_bf16 v[148:151], v[232:235], v[64:67], 0
    v_exp_f32 v117, v117
    v_cvt_pk_bf16_f32 v105, v114, v115
    v_fmamk_f32 v120, v120, 0x3e0293ee, v254
    v_mfma_f32_16x16x32_bf16 v[148:151], v[236:239], v[72:75], v[148:151]
    v_exp_f32 v118, v118
    v_fmamk_f32 v121, v121, 0x3e0293ee, v254
    v_exp_f32 v119, v119
    s_waitcnt lgkmcnt(4)
    v_mfma_f32_16x16x32_bf16 v[148:151], v[240:243], v[80:83], v[148:151]
    v_cvt_pk_bf16_f32 v106, v116, v117
    v_fmamk_f32 v122, v122, 0x3e0293ee, v254
    v_exp_f32 v120, v120
    v_mfma_f32_16x16x32_bf16 v[148:151], v[244:247], v[88:91], v[148:151]
    v_fmamk_f32 v123, v123, 0x3e0293ee, v254
    v_exp_f32 v121, v121
    v_mfma_f32_16x16x32_bf16 v[156:159], v[232:235], v[68:71], 0
    v_cvt_pk_bf16_f32 v107, v118, v119
    v_fmamk_f32 v124, v124, 0x3e0293ee, v254
    v_exp_f32 v122, v122
    v_fmamk_f32 v125, v125, 0x3e0293ee, v254
    v_mfma_f32_16x16x32_bf16 v[156:159], v[236:239], v[76:79], v[156:159]
    v_exp_f32 v123, v123
    v_cvt_pk_bf16_f32 v108, v120, v121
    v_fmamk_f32 v126, v126, 0x3e0293ee, v254
    v_mfma_f32_16x16x32_bf16 v[156:159], v[240:243], v[84:87], v[156:159]
    ds_read_b64_tr_b16 v[228:229], v25 offset:0
    ds_read_b64_tr_b16 v[230:231], v25 offset:4096
    v_exp_f32 v124, v124
    v_fmamk_f32 v127, v127, 0x3e0293ee, v254
    v_exp_f32 v125, v125
    v_mfma_f32_16x16x32_bf16 v[156:159], v[244:247], v[92:95], v[156:159]
    ds_read_b64_tr_b16 v[232:233], v25 offset:8192
    ds_read_b64_tr_b16 v[234:235], v25 offset:12288
    v_cvt_pk_bf16_f32 v109, v122, v123
    v_exp_f32 v126, v126
    s_waitcnt lgkmcnt(4)
    v_mfma_f32_16x16x32_bf16 v[160:163], v[248:251], v[96:99], 0
    v_exp_f32 v127, v127
    v_cvt_pk_bf16_f32 v110, v124, v125
    v_cvt_pk_bf16_f32 v111, v126, v127
    ds_write2st64_b64 v6, v[32:33], v[34:35] offset0:0 offset1:4
    v_mfma_f32_16x16x32_bf16 v[160:163], v[224:227], v[104:107], v[160:163]
    v_fmamk_f32 v128, v128, 0x3e0293ee, v253
    v_fmamk_f32 v129, v129, 0x3e0293ee, v253
    v_mfma_f32_16x16x32_bf16 v[164:167], v[248:251], v[100:103], 0
    ds_read_b64_tr_b16 v[236:237], v26 offset:0
    ds_read_b64_tr_b16 v[238:239], v26 offset:4096
    v_fmamk_f32 v130, v130, 0x3e0293ee, v253
    v_mfma_f32_16x16x32_bf16 v[164:167], v[224:227], v[108:111], v[164:167]
    ds_read_b64_tr_b16 v[240:241], v26 offset:8192
    ds_read_b64_tr_b16 v[242:243], v26 offset:12288
    v_exp_f32 v128, v128
    v_mfma_f32_16x16x32_bf16 v[12:15], v[8:11], v[96:99], 0
    v_fmamk_f32 v131, v131, 0x3e0293ee, v253
    v_mfma_f32_16x16x32_bf16 v[12:15], v[8:11], v[104:107], v[12:15]
    v_exp_f32 v129, v129
    v_mfma_f32_16x16x32_bf16 v[16:19], v[8:11], v[100:103], 0
    ds_read_b64_tr_b16 v[244:245], v27 offset:0
    ds_read_b64_tr_b16 v[246:247], v27 offset:4096
    v_xor_b32 v255, 32, v6
    ds_write2st64_b64 v255, v[36:37], v[38:39] offset0:0 offset1:4
    v_mfma_f32_16x16x32_bf16 v[16:19], v[8:11], v[108:111], v[16:19]
    ds_read_b64_tr_b16 v[248:249], v27 offset:8192
    ds_read_b64_tr_b16 v[250:251], v27 offset:12288
    v_fmamk_f32 v132, v132, 0x3e0293ee, v253
    s_waitcnt lgkmcnt(10)
    v_mfma_f32_16x16x32_bf16 v[168:171], v[228:231], v[96:99], 0
    s_add_u32 m0, s30, 106496
    s_add_u32 s31, s29, 40960
    buffer_load_dwordx4 v3, s[20:23], s31 offen offset:0 nt lds
    v_exp_f32 v130, v130
    v_mfma_f32_16x16x32_bf16 v[168:171], v[232:235], v[104:107], v[168:171]
    v_fmamk_f32 v133, v133, 0x3e0293ee, v253
    v_mfma_f32_16x16x32_bf16 v[172:175], v[228:231], v[100:103], 0
    ds_read_b64_tr_b16 v[224:225], v28 offset:0
    ds_read_b64_tr_b16 v[226:227], v28 offset:4096
    v_exp_f32 v131, v131
    v_cvt_pk_bf16_f32 v128, v128, v129
    v_mfma_f32_16x16x32_bf16 v[172:175], v[232:235], v[108:111], v[172:175]
    ds_read_b64_tr_b16 v[228:229], v28 offset:8192
    ds_read_b64_tr_b16 v[230:231], v28 offset:12288
    v_fmamk_f32 v134, v134, 0x3e0293ee, v253
    s_waitcnt lgkmcnt(9)
    v_mfma_f32_16x16x32_bf16 v[176:179], v[236:239], v[96:99], 0
    v_xor_b32 v255, 64, v6
    ds_write2st64_b64 v255, v[40:41], v[42:43] offset0:0 offset1:4
    v_mfma_f32_16x16x32_bf16 v[176:179], v[240:243], v[104:107], v[176:179]
    v_exp_f32 v132, v132
    v_mfma_f32_16x16x32_bf16 v[180:183], v[236:239], v[100:103], 0
    ds_read_b64_tr_b16 v[232:233], v29 offset:0
    ds_read_b64_tr_b16 v[234:235], v29 offset:4096
    v_fmamk_f32 v135, v135, 0x3e0293ee, v253
    v_mfma_f32_16x16x32_bf16 v[180:183], v[240:243], v[108:111], v[180:183]
    ds_read_b64_tr_b16 v[236:237], v29 offset:8192
    ds_read_b64_tr_b16 v[238:239], v29 offset:12288
    v_exp_f32 v133, v133
    s_waitcnt lgkmcnt(9)
    v_mfma_f32_16x16x32_bf16 v[184:187], v[244:247], v[96:99], 0
    v_cvt_pk_bf16_f32 v129, v130, v131
    v_fmamk_f32 v136, v136, 0x3e0293ee, v254
    v_mfma_f32_16x16x32_bf16 v[184:187], v[248:251], v[104:107], v[184:187]
    v_exp_f32 v134, v134
    v_mfma_f32_16x16x32_bf16 v[188:191], v[244:247], v[100:103], 0
    ds_read_b64_tr_b16 v[240:241], v30 offset:0
    ds_read_b64_tr_b16 v[242:243], v30 offset:4096
    v_xor_b32 v255, 96, v6
    ds_write2st64_b64 v255, v[44:45], v[46:47] offset0:0 offset1:4
    v_mfma_f32_16x16x32_bf16 v[188:191], v[248:251], v[108:111], v[188:191]
    ds_read_b64_tr_b16 v[244:245], v30 offset:8192
    ds_read_b64_tr_b16 v[246:247], v30 offset:12288
    v_fmamk_f32 v137, v137, 0x3e0293ee, v254
    s_waitcnt lgkmcnt(10)
    v_mfma_f32_16x16x32_bf16 v[192:195], v[224:227], v[96:99], 0
    v_exp_f32 v135, v135
    v_mfma_f32_16x16x32_bf16 v[192:195], v[228:231], v[104:107], v[192:195]
    ds_read_b128 v[32:35], v7 offset:0
    v_mfma_f32_16x16x32_bf16 v[196:199], v[224:227], v[100:103], 0
    ds_read_b64_tr_b16 v[248:249], v31 offset:0
    ds_read_b64_tr_b16 v[250:251], v31 offset:4096
    v_cvt_pk_bf16_f32 v130, v132, v133
    v_fmamk_f32 v138, v138, 0x3e0293ee, v254
    v_mfma_f32_16x16x32_bf16 v[196:199], v[228:231], v[108:111], v[196:199]
    ds_read_b64_tr_b16 v[224:225], v31 offset:8192
    ds_read_b64_tr_b16 v[226:227], v31 offset:12288
    v_exp_f32 v136, v136
    s_waitcnt lgkmcnt(10)
    v_mfma_f32_16x16x32_bf16 v[200:203], v[232:235], v[96:99], 0
    ds_read_b128 v[36:39], v7 offset:1024
    v_mfma_f32_16x16x32_bf16 v[200:203], v[236:239], v[104:107], v[200:203]
    v_fmamk_f32 v139, v139, 0x3e0293ee, v254
    v_mfma_f32_16x16x32_bf16 v[204:207], v[232:235], v[100:103], 0
    s_waitcnt vmcnt(6)
    s_barrier
    ds_read_b128 v[228:231], v20 offset:32768
    s_add_u32 m0, s30, 114688
    s_add_u32 s31, s29, 49152
    buffer_load_dwordx4 v3, s[20:23], s31 offen offset:0 nt lds
    v_exp_f32 v137, v137
    v_mfma_f32_16x16x32_bf16 v[204:207], v[236:239], v[108:111], v[204:207]
    ds_read_b128 v[232:235], v21 offset:32768
    ds_read_b128 v[40:43], v7 offset:2048
    v_cvt_pk_bf16_f32 v131, v134, v135
    s_waitcnt lgkmcnt(9)
    v_mfma_f32_16x16x32_bf16 v[208:211], v[240:243], v[96:99], 0
    ds_read_b128 v[236:239], v22 offset:32768
    v_fmamk_f32 v140, v140, 0x3e0293ee, v254
    v_mfma_f32_16x16x32_bf16 v[208:211], v[244:247], v[104:107], v[208:211]
    v_exp_f32 v138, v138
    v_mfma_f32_16x16x32_bf16 v[212:215], v[240:243], v[100:103], 0
    ds_read_b128 v[240:243], v23 offset:32768
    ds_read_b128 v[44:47], v7 offset:3072
    v_mfma_f32_16x16x32_bf16 v[212:215], v[244:247], v[108:111], v[212:215]
    v_fmamk_f32 v141, v141, 0x3e0293ee, v254
    s_waitcnt lgkmcnt(7)
    v_mfma_f32_16x16x32_bf16 v[216:219], v[248:251], v[96:99], 0
    v_exp_f32 v139, v139
    v_cvt_pk_bf16_f32 v132, v136, v137
    v_mfma_f32_16x16x32_bf16 v[216:219], v[224:227], v[104:107], v[216:219]
    v_fmamk_f32 v142, v142, 0x3e0293ee, v254
    v_mfma_f32_16x16x32_bf16 v[220:223], v[248:251], v[100:103], 0
    ds_read_b128 v[244:247], v20 offset:36864
    v_exp_f32 v140, v140
    v_mfma_f32_16x16x32_bf16 v[220:223], v[224:227], v[108:111], v[220:223]
    ds_read_b128 v[248:251], v21 offset:36864
    v_fmamk_f32 v143, v143, 0x3e0293ee, v254
    s_waitcnt lgkmcnt(6)
    v_mfma_f32_16x16x32_bf16 v[96:99], v[228:231], v[64:67], 0
    ds_read_b128 v[224:227], v22 offset:36864
    ds_write2st64_b64 v6, v[48:49], v[50:51] offset0:0 offset1:4
    v_exp_f32 v141, v141
    v_mfma_f32_16x16x32_bf16 v[96:99], v[232:235], v[72:75], v[96:99]
    v_cvt_pk_bf16_f32 v133, v138, v139
    s_waitcnt lgkmcnt(5)
    v_mfma_f32_16x16x32_bf16 v[96:99], v[236:239], v[80:83], v[96:99]
    v_fmamk_f32 v144, v144, 0x3e0293ee, v253
    v_exp_f32 v142, v142
    v_mfma_f32_16x16x32_bf16 v[96:99], v[240:243], v[88:91], v[96:99]
    v_fmamk_f32 v145, v145, 0x3e0293ee, v253
    v_mfma_f32_16x16x32_bf16 v[104:107], v[228:231], v[68:71], 0
    ds_read_b128 v[228:231], v23 offset:36864
    v_exp_f32 v143, v143
    v_mfma_f32_16x16x32_bf16 v[104:107], v[232:235], v[76:79], v[104:107]
    v_cvt_pk_bf16_f32 v134, v140, v141
    v_fmamk_f32 v146, v146, 0x3e0293ee, v253
    v_mfma_f32_16x16x32_bf16 v[104:107], v[236:239], v[84:87], v[104:107]
    ds_read_b128 v[232:235], v20 offset:40960
    s_add_u32 m0, s30, 122880
    s_add_u32 s31, s29, 57344
    buffer_load_dwordx4 v3, s[20:23], s31 offen offset:0 nt lds
    v_xor_b32 v255, 32, v6
    ds_write2st64_b64 v255, v[52:53], v[54:55] offset0:0 offset1:4
    v_mfma_f32_16x16x32_bf16 v[104:107], v[240:243], v[92:95], v[104:107]
    ds_read_b128 v[236:239], v21 offset:40960
    v_exp_f32 v144, v144
    v_fmamk_f32 v147, v147, 0x3e0293ee, v253
    s_waitcnt lgkmcnt(6)
    v_mfma_f32_16x16x32_bf16 v[100:103], v[244:247], v[64:67], 0
    ds_read_b128 v[240:243], v22 offset:40960
    v_exp_f32 v145, v145
    v_mfma_f32_16x16x32_bf16 v[100:103], v[248:251], v[72:75], v[100:103]
    v_cvt_pk_bf16_f32 v135, v142, v143
    v_fmamk_f32 v148, v148, 0x3e0293ee, v253
    s_waitcnt lgkmcnt(4)
    v_mfma_f32_16x16x32_bf16 v[100:103], v[224:227], v[80:83], v[100:103]
    v_exp_f32 v146, v146
    v_mfma_f32_16x16x32_bf16 v[100:103], v[228:231], v[88:91], v[100:103]
    v_fmamk_f32 v149, v149, 0x3e0293ee, v253
    v_mfma_f32_16x16x32_bf16 v[108:111], v[244:247], v[68:71], 0
    ds_read_b128 v[244:247], v23 offset:40960
    v_xor_b32 v255, 64, v6
    ds_write2st64_b64 v255, v[56:57], v[58:59] offset0:0 offset1:4
    v_exp_f32 v147, v147
    v_mfma_f32_16x16x32_bf16 v[108:111], v[248:251], v[76:79], v[108:111]
    v_cvt_pk_bf16_f32 v136, v144, v145
    v_mfma_f32_16x16x32_bf16 v[108:111], v[224:227], v[84:87], v[108:111]
    ds_read_b128 v[248:251], v20 offset:45056
    v_fmamk_f32 v150, v150, 0x3e0293ee, v253
    v_exp_f32 v148, v148
    v_mfma_f32_16x16x32_bf16 v[108:111], v[228:231], v[92:95], v[108:111]
    ds_read_b128 v[224:227], v21 offset:45056
    v_fmamk_f32 v151, v151, 0x3e0293ee, v253
    s_waitcnt lgkmcnt(5)
    v_mfma_f32_16x16x32_bf16 v[112:115], v[232:235], v[64:67], 0
    ds_read_b128 v[228:231], v22 offset:45056
    v_exp_f32 v149, v149
    v_cvt_pk_bf16_f32 v137, v146, v147
    v_mfma_f32_16x16x32_bf16 v[112:115], v[236:239], v[72:75], v[112:115]
    v_fmamk_f32 v152, v152, 0x3e0293ee, v254
    s_waitcnt lgkmcnt(4)
    v_mfma_f32_16x16x32_bf16 v[112:115], v[240:243], v[80:83], v[112:115]
    v_xor_b32 v255, 96, v6
    ds_write2st64_b64 v255, v[60:61], v[62:63] offset0:0 offset1:4
    v_exp_f32 v150, v150
    v_mfma_f32_16x16x32_bf16 v[112:115], v[244:247], v[88:91], v[112:115]
    v_fmamk_f32 v153, v153, 0x3e0293ee, v254
    v_mfma_f32_16x16x32_bf16 v[120:123], v[232:235], v[68:71], 0
    ds_read_b128 v[232:235], v23 offset:45056
    v_exp_f32 v151, v151
    v_cvt_pk_bf16_f32 v138, v148, v149
    v_mfma_f32_16x16x32_bf16 v[120:123], v[236:239], v[76:79], v[120:123]
    ds_read_b128 v[48:51], v7 offset:0
    v_fmamk_f32 v154, v154, 0x3e0293ee, v254
    v_mfma_f32_16x16x32_bf16 v[120:123], v[240:243], v[84:87], v[120:123]
    s_waitcnt vmcnt(6)
    s_barrier
    ds_read_b64_tr_b16 v[236:237], v24 offset:16384
    ds_read_b64_tr_b16 v[238:239], v24 offset:20480
    v_exp_f32 v152, v152
    v_fmamk_f32 v155, v155, 0x3e0293ee, v254
    v_mfma_f32_16x16x32_bf16 v[120:123], v[244:247], v[92:95], v[120:123]
    ds_read_b64_tr_b16 v[240:241], v24 offset:24576
    ds_read_b64_tr_b16 v[242:243], v24 offset:28672
    v_exp_f32 v153, v153
    s_waitcnt lgkmcnt(8)
    v_mfma_f32_16x16x32_bf16 v[116:119], v[248:251], v[64:67], 0
    ds_read_b128 v[52:55], v7 offset:1024
    v_cvt_pk_bf16_f32 v139, v150, v151
    v_mfma_f32_16x16x32_bf16 v[116:119], v[224:227], v[72:75], v[116:119]
    v_fmamk_f32 v156, v156, 0x3e0293ee, v254
    v_exp_f32 v154, v154
    s_waitcnt lgkmcnt(6)
    v_mfma_f32_16x16x32_bf16 v[116:119], v[228:231], v[80:83], v[116:119]
    v_fmamk_f32 v157, v157, 0x3e0293ee, v254
    v_exp_f32 v155, v155
    v_mfma_f32_16x16x32_bf16 v[116:119], v[232:235], v[88:91], v[116:119]
    ds_read_b128 v[56:59], v7 offset:2048
    v_cvt_pk_bf16_f32 v140, v152, v153
    v_mfma_f32_16x16x32_bf16 v[124:127], v[248:251], v[68:71], 0
    v_fmamk_f32 v158, v158, 0x3e0293ee, v254
    v_exp_f32 v156, v156
    v_mfma_f32_16x16x32_bf16 v[124:127], v[224:227], v[76:79], v[124:127]
    v_fmamk_f32 v159, v159, 0x3e0293ee, v254
    v_exp_f32 v157, v157
    v_mfma_f32_16x16x32_bf16 v[124:127], v[228:231], v[84:87], v[124:127]
    ds_read_b64_tr_b16 v[244:245], v25 offset:16384
    ds_read_b64_tr_b16 v[246:247], v25 offset:20480
    ds_read_b128 v[60:63], v7 offset:3072
    v_cvt_pk_bf16_f32 v141, v154, v155
    v_mfma_f32_16x16x32_bf16 v[124:127], v[232:235], v[92:95], v[124:127]
    ds_read_b64_tr_b16 v[248:249], v25 offset:24576
    ds_read_b64_tr_b16 v[250:251], v25 offset:28672
    v_exp_f32 v158, v158
    v_exp_f32 v159, v159
    s_waitcnt lgkmcnt(7)
    v_mfma_f32_16x16x32_bf16 v[160:163], v[236:239], v[128:131], v[160:163]
    v_cvt_pk_bf16_f32 v142, v156, v157
    v_cvt_pk_bf16_f32 v143, v158, v159
    buffer_store_dwordx4 v[32:35], v252, s[24:27], s28 offen offset:0 nt
    v_mfma_f32_16x16x32_bf16 v[160:163], v[240:243], v[136:139], v[160:163]
    v_fmamk_f32 v96, v96, 0x3e0293ee, v253
    v_mfma_f32_16x16x32_bf16 v[164:167], v[236:239], v[132:135], v[164:167]
    ds_read_b64_tr_b16 v[224:225], v26 offset:16384
    ds_read_b64_tr_b16 v[226:227], v26 offset:20480
    v_fmamk_f32 v97, v97, 0x3e0293ee, v253
    v_fmamk_f32 v98, v98, 0x3e0293ee, v253
    v_mfma_f32_16x16x32_bf16 v[164:167], v[240:243], v[140:143], v[164:167]
    ds_read_b64_tr_b16 v[228:229], v26 offset:24576
    ds_read_b64_tr_b16 v[230:231], v26 offset:28672
    v_exp_f32 v96, v96
    v_mfma_f32_16x16x32_bf16 v[12:15], v[8:11], v[128:131], v[12:15]
    v_fmamk_f32 v99, v99, 0x3e0293ee, v253
    v_mfma_f32_16x16x32_bf16 v[12:15], v[8:11], v[136:139], v[12:15]
    v_exp_f32 v97, v97
    v_mfma_f32_16x16x32_bf16 v[16:19], v[8:11], v[132:135], v[16:19]
    ds_read_b64_tr_b16 v[232:233], v27 offset:16384
    ds_read_b64_tr_b16 v[234:235], v27 offset:20480
    v_fmamk_f32 v100, v100, 0x3e0293ee, v253
    v_mfma_f32_16x16x32_bf16 v[16:19], v[8:11], v[140:143], v[16:19]
    ds_read_b64_tr_b16 v[236:237], v27 offset:24576
    ds_read_b64_tr_b16 v[238:239], v27 offset:28672
    v_exp_f32 v98, v98
    s_waitcnt lgkmcnt(8)
    v_mfma_f32_16x16x32_bf16 v[168:171], v[244:247], v[128:131], v[168:171]
    v_fmamk_f32 v101, v101, 0x3e0293ee, v253
    v_mfma_f32_16x16x32_bf16 v[168:171], v[248:251], v[136:139], v[168:171]
    buffer_store_dwordx4 v[36:39], v252, s[24:27], s28 offen offset:2048 nt
    v_exp_f32 v99, v99
    v_mfma_f32_16x16x32_bf16 v[172:175], v[244:247], v[132:135], v[172:175]
    ds_read_b64_tr_b16 v[240:241], v28 offset:16384
    ds_read_b64_tr_b16 v[242:243], v28 offset:20480
    v_cvt_pk_bf16_f32 v96, v96, v97
    v_mfma_f32_16x16x32_bf16 v[172:175], v[248:251], v[140:143], v[172:175]
    ds_read_b64_tr_b16 v[244:245], v28 offset:24576
    ds_read_b64_tr_b16 v[246:247], v28 offset:28672
    v_fmamk_f32 v102, v102, 0x3e0293ee, v253
    s_waitcnt lgkmcnt(8)
    v_mfma_f32_16x16x32_bf16 v[176:179], v[224:227], v[128:131], v[176:179]
    v_exp_f32 v100, v100
    v_mfma_f32_16x16x32_bf16 v[176:179], v[228:231], v[136:139], v[176:179]
    v_fmamk_f32 v103, v103, 0x3e0293ee, v253
    v_mfma_f32_16x16x32_bf16 v[180:183], v[224:227], v[132:135], v[180:183]
    ds_read_b64_tr_b16 v[248:249], v29 offset:16384
    ds_read_b64_tr_b16 v[250:251], v29 offset:20480
    v_exp_f32 v101, v101
    v_mfma_f32_16x16x32_bf16 v[180:183], v[228:231], v[140:143], v[180:183]
    ds_read_b64_tr_b16 v[224:225], v29 offset:24576
    ds_read_b64_tr_b16 v[226:227], v29 offset:28672
    v_cvt_pk_bf16_f32 v97, v98, v99
    v_fmamk_f32 v104, v104, 0x3e0293ee, v254
    s_waitcnt lgkmcnt(8)
    v_mfma_f32_16x16x32_bf16 v[184:187], v[232:235], v[128:131], v[184:187]
    v_exp_f32 v102, v102
    v_mfma_f32_16x16x32_bf16 v[184:187], v[236:239], v[136:139], v[184:187]
    v_fmamk_f32 v105, v105, 0x3e0293ee, v254
    v_mfma_f32_16x16x32_bf16 v[188:191], v[232:235], v[132:135], v[188:191]
    ds_read_b64_tr_b16 v[228:229], v30 offset:16384
    ds_read_b64_tr_b16 v[230:231], v30 offset:20480
    buffer_store_dwordx4 v[40:43], v252, s[24:27], s32 offen offset:0 nt
    v_mfma_f32_16x16x32_bf16 v[188:191], v[236:239], v[140:143], v[188:191]
    ds_read_b64_tr_b16 v[232:233], v30 offset:24576
    ds_read_b64_tr_b16 v[234:235], v30 offset:28672
    v_exp_f32 v103, v103
    s_waitcnt lgkmcnt(8)
    v_mfma_f32_16x16x32_bf16 v[192:195], v[240:243], v[128:131], v[192:195]
    v_cvt_pk_bf16_f32 v98, v100, v101
    v_fmamk_f32 v106, v106, 0x3e0293ee, v254
    v_mfma_f32_16x16x32_bf16 v[192:195], v[244:247], v[136:139], v[192:195]
    v_exp_f32 v104, v104
    v_mfma_f32_16x16x32_bf16 v[196:199], v[240:243], v[132:135], v[196:199]
    ds_read_b64_tr_b16 v[236:237], v31 offset:16384
    ds_read_b64_tr_b16 v[238:239], v31 offset:20480
    v_fmamk_f32 v107, v107, 0x3e0293ee, v254
    v_mfma_f32_16x16x32_bf16 v[196:199], v[244:247], v[140:143], v[196:199]
    ds_read_b64_tr_b16 v[240:241], v31 offset:24576
    ds_read_b64_tr_b16 v[242:243], v31 offset:28672
    v_exp_f32 v105, v105
    s_waitcnt lgkmcnt(8)
    v_mfma_f32_16x16x32_bf16 v[200:203], v[248:251], v[128:131], v[200:203]
    v_cvt_pk_bf16_f32 v99, v102, v103
    v_mfma_f32_16x16x32_bf16 v[200:203], v[224:227], v[136:139], v[200:203]
    v_fmamk_f32 v108, v108, 0x3e0293ee, v254
    v_mfma_f32_16x16x32_bf16 v[204:207], v[248:251], v[132:135], v[204:207]
    s_waitcnt vmcnt(7)
    s_barrier
    ds_read_b128 v[244:247], v20 offset:49152
    v_exp_f32 v106, v106
    v_mfma_f32_16x16x32_bf16 v[204:207], v[224:227], v[140:143], v[204:207]
    ds_read_b128 v[248:251], v21 offset:49152
    buffer_store_dwordx4 v[44:47], v252, s[24:27], s32 offen offset:2048 nt
    v_fmamk_f32 v109, v109, 0x3e0293ee, v254
    s_waitcnt lgkmcnt(6)
    v_mfma_f32_16x16x32_bf16 v[208:211], v[228:231], v[128:131], v[208:211]
    ds_read_b128 v[224:227], v22 offset:49152
    v_exp_f32 v107, v107
    v_mfma_f32_16x16x32_bf16 v[208:211], v[232:235], v[136:139], v[208:211]
    v_cvt_pk_bf16_f32 v100, v104, v105
    v_mfma_f32_16x16x32_bf16 v[212:215], v[228:231], v[132:135], v[212:215]
    ds_read_b128 v[228:231], v23 offset:49152
    v_fmamk_f32 v110, v110, 0x3e0293ee, v254
    v_mfma_f32_16x16x32_bf16 v[212:215], v[232:235], v[140:143], v[212:215]
    v_exp_f32 v108, v108
    s_waitcnt lgkmcnt(4)
    v_mfma_f32_16x16x32_bf16 v[216:219], v[236:239], v[128:131], v[216:219]
    v_fmamk_f32 v111, v111, 0x3e0293ee, v254
    v_mfma_f32_16x16x32_bf16 v[216:219], v[240:243], v[136:139], v[216:219]
    v_exp_f32 v109, v109
    v_mfma_f32_16x16x32_bf16 v[220:223], v[236:239], v[132:135], v[220:223]
    ds_read_b128 v[232:235], v20 offset:53248
    v_cvt_pk_bf16_f32 v101, v106, v107
    v_fmamk_f32 v112, v112, 0x3e0293ee, v253
    v_mfma_f32_16x16x32_bf16 v[220:223], v[240:243], v[140:143], v[220:223]
    ds_read_b128 v[236:239], v21 offset:53248
    v_exp_f32 v110, v110
    s_waitcnt lgkmcnt(4)
    v_mfma_f32_16x16x32_bf16 v[128:131], v[244:247], v[64:67], 0
    ds_read_b128 v[240:243], v22 offset:53248
    buffer_store_dwordx4 v[48:51], v252, s[24:27], s28 offen offset:128 nt
    v_fmamk_f32 v113, v113, 0x3e0293ee, v253
    v_mfma_f32_16x16x32_bf16 v[128:131], v[248:251], v[72:75], v[128:131]
    v_exp_f32 v111, v111
    s_waitcnt lgkmcnt(3)
    v_mfma_f32_16x16x32_bf16 v[128:131], v[224:227], v[80:83], v[128:131]
    v_cvt_pk_bf16_f32 v102, v108, v109
    v_fmamk_f32 v114, v114, 0x3e0293ee, v253
    v_mfma_f32_16x16x32_bf16 v[128:131], v[228:231], v[88:91], v[128:131]
    v_exp_f32 v112, v112
    v_mfma_f32_16x16x32_bf16 v[136:139], v[244:247], v[68:71], 0
    ds_read_b128 v[244:247], v23 offset:53248
    v_fmamk_f32 v115, v115, 0x3e0293ee, v253
    v_mfma_f32_16x16x32_bf16 v[136:139], v[248:251], v[76:79], v[136:139]
    v_exp_f32 v113, v113
    v_cvt_pk_bf16_f32 v103, v110, v111
    v_mfma_f32_16x16x32_bf16 v[136:139], v[224:227], v[84:87], v[136:139]
    ds_read_b128 v[248:251], v20 offset:57344
    v_fmamk_f32 v116, v116, 0x3e0293ee, v253
    v_mfma_f32_16x16x32_bf16 v[136:139], v[228:231], v[92:95], v[136:139]
    ds_read_b128 v[224:227], v21 offset:57344
    v_exp_f32 v114, v114
    v_fmamk_f32 v117, v117, 0x3e0293ee, v253
    s_waitcnt lgkmcnt(4)
    v_mfma_f32_16x16x32_bf16 v[132:135], v[232:235], v[64:67], 0
    ds_read_b128 v[228:231], v22 offset:57344
    v_exp_f32 v115, v115
    v_mfma_f32_16x16x32_bf16 v[132:135], v[236:239], v[72:75], v[132:135]
    buffer_store_dwordx4 v[52:55], v252, s[24:27], s28 offen offset:2176 nt
    v_cvt_pk_bf16_f32 v104, v112, v113
    s_waitcnt lgkmcnt(3)
    v_mfma_f32_16x16x32_bf16 v[132:135], v[240:243], v[80:83], v[132:135]
    v_fmamk_f32 v118, v118, 0x3e0293ee, v253
    v_mfma_f32_16x16x32_bf16 v[132:135], v[244:247], v[88:91], v[132:135]
    v_exp_f32 v116, v116
    v_fmamk_f32 v119, v119, 0x3e0293ee, v253
    v_mfma_f32_16x16x32_bf16 v[140:143], v[232:235], v[68:71], 0
    ds_read_b128 v[232:235], v23 offset:57344
    v_exp_f32 v117, v117
    v_mfma_f32_16x16x32_bf16 v[140:143], v[236:239], v[76:79], v[140:143]
    v_cvt_pk_bf16_f32 v105, v114, v115
    v_fmamk_f32 v120, v120, 0x3e0293ee, v254
    v_mfma_f32_16x16x32_bf16 v[140:143], v[240:243], v[84:87], v[140:143]
    ds_read_b128 v[236:239], v20 offset:61440
    v_exp_f32 v118, v118
    v_mfma_f32_16x16x32_bf16 v[140:143], v[244:247], v[92:95], v[140:143]
    ds_read_b128 v[240:243], v21 offset:61440
    v_fmamk_f32 v121, v121, 0x3e0293ee, v254
    s_waitcnt lgkmcnt(4)
    v_mfma_f32_16x16x32_bf16 v[144:147], v[248:251], v[64:67], 0
    ds_read_b128 v[244:247], v22 offset:61440
    v_exp_f32 v119, v119
    v_cvt_pk_bf16_f32 v106, v116, v117
    v_mfma_f32_16x16x32_bf16 v[144:147], v[224:227], v[72:75], v[144:147]
    v_fmamk_f32 v122, v122, 0x3e0293ee, v254
    s_waitcnt lgkmcnt(3)
    v_mfma_f32_16x16x32_bf16 v[144:147], v[228:231], v[80:83], v[144:147]
    buffer_store_dwordx4 v[56:59], v252, s[24:27], s32 offen offset:128 nt
    v_exp_f32 v120, v120
    v_mfma_f32_16x16x32_bf16 v[144:147], v[232:235], v[88:91], v[144:147]
    v_fmamk_f32 v123, v123, 0x3e0293ee, v254
    v_exp_f32 v121, v121
    v_mfma_f32_16x16x32_bf16 v[152:155], v[248:251], v[68:71], 0
    ds_read_b128 v[248:251], v23 offset:61440
    v_cvt_pk_bf16_f32 v107, v118, v119
    v_fmamk_f32 v124, v124, 0x3e0293ee, v254
    v_mfma_f32_16x16x32_bf16 v[152:155], v[224:227], v[76:79], v[152:155]
    v_exp_f32 v122, v122
    v_fmamk_f32 v125, v125, 0x3e0293ee, v254
    v_mfma_f32_16x16x32_bf16 v[152:155], v[228:231], v[84:87], v[152:155]
    s_waitcnt vmcnt(9)
    s_waitcnt vmcnt(7)
    s_barrier
    ds_read_b64_tr_b16 v[224:225], v24 offset:32768
    ds_read_b64_tr_b16 v[226:227], v24 offset:36864
    v_exp_f32 v123, v123
    v_mfma_f32_16x16x32_bf16 v[152:155], v[232:235], v[92:95], v[152:155]
    ds_read_b64_tr_b16 v[228:229], v24 offset:40960
    ds_read_b64_tr_b16 v[230:231], v24 offset:45056
    v_cvt_pk_bf16_f32 v108, v120, v121
    v_fmamk_f32 v126, v126, 0x3e0293ee, v254
    s_waitcnt lgkmcnt(6)
    v_mfma_f32_16x16x32_bf16 v[148:151], v[236:239], v[64:67], 0
    v_exp_f32 v124, v124
    v_fmamk_f32 v127, v127, 0x3e0293ee, v254
    v_mfma_f32_16x16x32_bf16 v[148:151], v[240:243], v[72:75], v[148:151]
    v_exp_f32 v125, v125
    v_cvt_pk_bf16_f32 v109, v122, v123
    s_waitcnt lgkmcnt(4)
    v_mfma_f32_16x16x32_bf16 v[148:151], v[244:247], v[80:83], v[148:151]
    v_exp_f32 v126, v126
    v_mfma_f32_16x16x32_bf16 v[148:151], v[248:251], v[88:91], v[148:151]
    buffer_store_dwordx4 v[60:63], v252, s[24:27], s32 offen offset:2176 nt
    v_exp_f32 v127, v127
    v_mfma_f32_16x16x32_bf16 v[156:159], v[236:239], v[68:71], 0
    v_cvt_pk_bf16_f32 v110, v124, v125
    v_cvt_pk_bf16_f32 v111, v126, v127
    v_fmamk_f32 v128, v128, 0x3e0293ee, v253
    v_mfma_f32_16x16x32_bf16 v[156:159], v[240:243], v[76:79], v[156:159]
    v_fmamk_f32 v129, v129, 0x3e0293ee, v253
    v_fmamk_f32 v130, v130, 0x3e0293ee, v253
    v_mfma_f32_16x16x32_bf16 v[156:159], v[244:247], v[84:87], v[156:159]
    ds_read_b64_tr_b16 v[232:233], v25 offset:32768
    ds_read_b64_tr_b16 v[234:235], v25 offset:36864
    v_exp_f32 v128, v128
    v_fmamk_f32 v131, v131, 0x3e0293ee, v253
    v_mfma_f32_16x16x32_bf16 v[156:159], v[248:251], v[92:95], v[156:159]
    ds_read_b64_tr_b16 v[236:237], v25 offset:40960
    ds_read_b64_tr_b16 v[238:239], v25 offset:45056
    v_exp_f32 v129, v129
    v_fmamk_f32 v132, v132, 0x3e0293ee, v253
    s_waitcnt lgkmcnt(4)
    v_mfma_f32_16x16x32_bf16 v[160:163], v[224:227], v[96:99], v[160:163]
    v_exp_f32 v130, v130
    v_mfma_f32_16x16x32_bf16 v[160:163], v[228:231], v[104:107], v[160:163]
    v_fmamk_f32 v133, v133, 0x3e0293ee, v253
    v_mfma_f32_16x16x32_bf16 v[164:167], v[224:227], v[100:103], v[164:167]
    ds_read_b64_tr_b16 v[240:241], v26 offset:32768
    ds_read_b64_tr_b16 v[242:243], v26 offset:36864
    v_exp_f32 v131, v131
    v_cvt_pk_bf16_f32 v128, v128, v129
    v_fmamk_f32 v134, v134, 0x3e0293ee, v253
    v_exp_f32 v132, v132
    v_mfma_f32_16x16x32_bf16 v[164:167], v[228:231], v[108:111], v[164:167]
    ds_read_b64_tr_b16 v[244:245], v26 offset:40960
    ds_read_b64_tr_b16 v[246:247], v26 offset:45056
    v_fmamk_f32 v135, v135, 0x3e0293ee, v253
    v_exp_f32 v133, v133
    v_cvt_pk_bf16_f32 v129, v130, v131
    v_fmamk_f32 v136, v136, 0x3e0293ee, v254
    v_mfma_f32_16x16x32_bf16 v[12:15], v[8:11], v[96:99], v[12:15]
    v_exp_f32 v134, v134
    v_fmamk_f32 v137, v137, 0x3e0293ee, v254
    v_exp_f32 v135, v135
    v_mfma_f32_16x16x32_bf16 v[12:15], v[8:11], v[104:107], v[12:15]
    v_cvt_pk_bf16_f32 v130, v132, v133
    v_fmamk_f32 v138, v138, 0x3e0293ee, v254
    v_exp_f32 v136, v136
    v_fmamk_f32 v139, v139, 0x3e0293ee, v254
    v_mfma_f32_16x16x32_bf16 v[16:19], v[8:11], v[100:103], v[16:19]
    ds_read_b64_tr_b16 v[248:249], v27 offset:32768
    ds_read_b64_tr_b16 v[250:251], v27 offset:36864
    v_exp_f32 v137, v137
    v_cvt_pk_bf16_f32 v131, v134, v135
    v_fmamk_f32 v140, v140, 0x3e0293ee, v254
    v_exp_f32 v138, v138
    v_mfma_f32_16x16x32_bf16 v[16:19], v[8:11], v[108:111], v[16:19]
    ds_read_b64_tr_b16 v[224:225], v27 offset:40960
    ds_read_b64_tr_b16 v[226:227], v27 offset:45056
    v_fmamk_f32 v141, v141, 0x3e0293ee, v254
    v_exp_f32 v139, v139
    v_cvt_pk_bf16_f32 v132, v136, v137
    v_fmamk_f32 v142, v142, 0x3e0293ee, v254
    s_waitcnt lgkmcnt(8)
    v_mfma_f32_16x16x32_bf16 v[168:171], v[232:235], v[96:99], v[168:171]
    v_exp_f32 v140, v140
    v_fmamk_f32 v143, v143, 0x3e0293ee, v254
    v_exp_f32 v141, v141
    v_mfma_f32_16x16x32_bf16 v[168:171], v[236:239], v[104:107], v[168:171]
    v_cvt_pk_bf16_f32 v133, v138, v139
    v_fmamk_f32 v144, v144, 0x3e0293ee, v253
    v_exp_f32 v142, v142
    v_fmamk_f32 v145, v145, 0x3e0293ee, v253
    v_mfma_f32_16x16x32_bf16 v[172:175], v[232:235], v[100:103], v[172:175]
    ds_read_b64_tr_b16 v[228:229], v24 offset:49152
    ds_read_b64_tr_b16 v[230:231], v24 offset:53248
    v_exp_f32 v143, v143
    v_cvt_pk_bf16_f32 v134, v140, v141
    v_fmamk_f32 v146, v146, 0x3e0293ee, v253
    v_exp_f32 v144, v144
    v_mfma_f32_16x16x32_bf16 v[172:175], v[236:239], v[108:111], v[172:175]
    ds_read_b64_tr_b16 v[232:233], v24 offset:57344
    ds_read_b64_tr_b16 v[234:235], v24 offset:61440
    v_fmamk_f32 v147, v147, 0x3e0293ee, v253
    v_exp_f32 v145, v145
    v_cvt_pk_bf16_f32 v135, v142, v143
    v_fmamk_f32 v148, v148, 0x3e0293ee, v253
    s_waitcnt lgkmcnt(8)
    v_mfma_f32_16x16x32_bf16 v[176:179], v[240:243], v[96:99], v[176:179]
    v_exp_f32 v146, v146
    v_fmamk_f32 v149, v149, 0x3e0293ee, v253
    v_exp_f32 v147, v147
    v_mfma_f32_16x16x32_bf16 v[176:179], v[244:247], v[104:107], v[176:179]
    v_cvt_pk_bf16_f32 v136, v144, v145
    v_fmamk_f32 v150, v150, 0x3e0293ee, v253
    v_exp_f32 v148, v148
    v_fmamk_f32 v151, v151, 0x3e0293ee, v253
    v_mfma_f32_16x16x32_bf16 v[180:183], v[240:243], v[100:103], v[180:183]
    v_exp_f32 v149, v149
    v_cvt_pk_bf16_f32 v137, v146, v147
    v_fmamk_f32 v152, v152, 0x3e0293ee, v254
    v_exp_f32 v150, v150
    v_mfma_f32_16x16x32_bf16 v[180:183], v[244:247], v[108:111], v[180:183]
    v_fmamk_f32 v153, v153, 0x3e0293ee, v254
    v_exp_f32 v151, v151
    v_cvt_pk_bf16_f32 v138, v148, v149
    v_fmamk_f32 v154, v154, 0x3e0293ee, v254
    s_waitcnt lgkmcnt(4)
    v_mfma_f32_16x16x32_bf16 v[184:187], v[248:251], v[96:99], v[184:187]
    v_exp_f32 v152, v152
    v_fmamk_f32 v155, v155, 0x3e0293ee, v254
    v_exp_f32 v153, v153
    v_mfma_f32_16x16x32_bf16 v[184:187], v[224:227], v[104:107], v[184:187]
    v_cvt_pk_bf16_f32 v139, v150, v151
    v_fmamk_f32 v156, v156, 0x3e0293ee, v254
    v_exp_f32 v154, v154
    v_fmamk_f32 v157, v157, 0x3e0293ee, v254
    v_mfma_f32_16x16x32_bf16 v[188:191], v[248:251], v[100:103], v[188:191]
    ds_read_b64_tr_b16 v[236:237], v25 offset:49152
    ds_read_b64_tr_b16 v[238:239], v25 offset:53248
    v_exp_f32 v155, v155
    v_cvt_pk_bf16_f32 v140, v152, v153
    v_fmamk_f32 v158, v158, 0x3e0293ee, v254
    v_exp_f32 v156, v156
    v_mfma_f32_16x16x32_bf16 v[188:191], v[224:227], v[108:111], v[188:191]
    ds_read_b64_tr_b16 v[240:241], v25 offset:57344
    ds_read_b64_tr_b16 v[242:243], v25 offset:61440
    v_fmamk_f32 v159, v159, 0x3e0293ee, v254
    v_exp_f32 v157, v157
    v_cvt_pk_bf16_f32 v141, v154, v155
    s_waitcnt lgkmcnt(4)
    v_mfma_f32_16x16x32_bf16 v[160:163], v[228:231], v[128:131], v[160:163]
    v_exp_f32 v158, v158
    v_exp_f32 v159, v159
    v_cvt_pk_bf16_f32 v142, v156, v157
    v_cvt_pk_bf16_f32 v143, v158, v159
    v_mfma_f32_16x16x32_bf16 v[160:163], v[232:235], v[136:139], v[160:163]
    v_mfma_f32_16x16x32_bf16 v[164:167], v[228:231], v[132:135], v[164:167]
    ds_read_b64_tr_b16 v[244:245], v26 offset:49152
    ds_read_b64_tr_b16 v[246:247], v26 offset:53248
    v_mfma_f32_16x16x32_bf16 v[164:167], v[232:235], v[140:143], v[164:167]
    ds_read_b64_tr_b16 v[248:249], v26 offset:57344
    ds_read_b64_tr_b16 v[250:251], v26 offset:61440
    v_mfma_f32_16x16x32_bf16 v[12:15], v[8:11], v[128:131], v[12:15]
    v_mfma_f32_16x16x32_bf16 v[12:15], v[8:11], v[136:139], v[12:15]
    v_mfma_f32_16x16x32_bf16 v[16:19], v[8:11], v[132:135], v[16:19]
    ds_read_b64_tr_b16 v[224:225], v27 offset:49152
    ds_read_b64_tr_b16 v[226:227], v27 offset:53248
    v_mfma_f32_16x16x32_bf16 v[16:19], v[8:11], v[140:143], v[16:19]
    ds_read_b64_tr_b16 v[228:229], v27 offset:57344
    ds_read_b64_tr_b16 v[230:231], v27 offset:61440
    s_waitcnt lgkmcnt(8)
    v_mfma_f32_16x16x32_bf16 v[168:171], v[236:239], v[128:131], v[168:171]
    v_mfma_f32_16x16x32_bf16 v[168:171], v[240:243], v[136:139], v[168:171]
    v_mfma_f32_16x16x32_bf16 v[172:175], v[236:239], v[132:135], v[172:175]
    ds_read_b64_tr_b16 v[232:233], v28 offset:32768
    ds_read_b64_tr_b16 v[234:235], v28 offset:36864
    v_max_f32 v14, v12, v16
    v_rcp_f32 v13, v12
    v_rcp_f32 v17, v16
    v_mfma_f32_16x16x32_bf16 v[172:175], v[240:243], v[140:143], v[172:175]
    ds_read_b64_tr_b16 v[236:237], v28 offset:40960
    ds_read_b64_tr_b16 v[238:239], v28 offset:45056
    v_cmp_ngt_f32 vcc, s44, v14
    v_mul_f32 v160, v13, v160
    v_mul_f32 v161, v13, v161
    v_mul_f32 v162, v13, v162
    s_waitcnt lgkmcnt(8)
    v_mfma_f32_16x16x32_bf16 v[176:179], v[244:247], v[128:131], v[176:179]
    ds_read_b64_tr_b16 v[240:241], v28 offset:49152
    ds_read_b64_tr_b16 v[242:243], v28 offset:53248
    v_mul_f32 v163, v13, v163
    v_cvt_pk_bf16_f32 v160, v160, v161
    v_mul_f32 v164, v17, v164
    v_mul_f32 v165, v17, v165
    v_mfma_f32_16x16x32_bf16 v[176:179], v[248:251], v[136:139], v[176:179]
    v_cvt_pk_bf16_f32 v161, v162, v163
    v_mul_f32 v166, v17, v166
    v_mul_f32 v167, v17, v167
    v_cvt_pk_bf16_f32 v162, v164, v165
    v_mfma_f32_16x16x32_bf16 v[180:183], v[244:247], v[132:135], v[180:183]
    ds_read_b64_tr_b16 v[244:245], v28 offset:57344
    ds_read_b64_tr_b16 v[246:247], v28 offset:61440
    v_cvt_pk_bf16_f32 v163, v166, v167
    s_cmp_lg_u64 vcc, 0
    s_cselect_b32 s36, 2, 0
    s_or_b32 s34, s34, s36
    ds_write2st64_b64 v6, v[160:161], v[162:163] offset0:0 offset1:4
    v_mul_f32 v168, v13, v168
    v_mfma_f32_16x16x32_bf16 v[180:183], v[248:251], v[140:143], v[180:183]
    v_mul_f32 v169, v13, v169
    v_mul_f32 v170, v13, v170
    v_mul_f32 v171, v13, v171
    v_cvt_pk_bf16_f32 v168, v168, v169
    s_waitcnt lgkmcnt(9)
    v_mfma_f32_16x16x32_bf16 v[184:187], v[224:227], v[128:131], v[184:187]
    v_mul_f32 v172, v17, v172
    v_mul_f32 v173, v17, v173
    v_cvt_pk_bf16_f32 v169, v170, v171
    v_mul_f32 v174, v17, v174
    v_mfma_f32_16x16x32_bf16 v[184:187], v[228:231], v[136:139], v[184:187]
    v_mul_f32 v175, v17, v175
    v_cvt_pk_bf16_f32 v170, v172, v173
    v_cvt_pk_bf16_f32 v171, v174, v175
    v_mfma_f32_16x16x32_bf16 v[188:191], v[224:227], v[132:135], v[188:191]
    ds_read_b64_tr_b16 v[248:249], v29 offset:32768
    ds_read_b64_tr_b16 v[250:251], v29 offset:36864
    v_xor_b32 v255, 32, v6
    ds_write2st64_b64 v255, v[168:169], v[170:171] offset0:0 offset1:4
    v_mul_f32 v176, v13, v176
    v_mul_f32 v177, v13, v177
    v_mul_f32 v178, v13, v178
    v_mfma_f32_16x16x32_bf16 v[188:191], v[228:231], v[140:143], v[188:191]
    ds_read_b64_tr_b16 v[224:225], v29 offset:40960
    ds_read_b64_tr_b16 v[226:227], v29 offset:45056
    v_mul_f32 v179, v13, v179
    v_cvt_pk_bf16_f32 v176, v176, v177
    v_mul_f32 v180, v17, v180
    v_mul_f32 v181, v17, v181
    s_waitcnt lgkmcnt(10)
    v_mfma_f32_16x16x32_bf16 v[192:195], v[232:235], v[96:99], v[192:195]
    ds_read_b64_tr_b16 v[228:229], v29 offset:49152
    ds_read_b64_tr_b16 v[230:231], v29 offset:53248
    v_cvt_pk_bf16_f32 v177, v178, v179
    v_mul_f32 v182, v17, v182
    v_mul_f32 v183, v17, v183
    v_cvt_pk_bf16_f32 v178, v180, v181
    v_mfma_f32_16x16x32_bf16 v[192:195], v[236:239], v[104:107], v[192:195]
    v_cvt_pk_bf16_f32 v179, v182, v183
    v_xor_b32 v255, 64, v6
    ds_write2st64_b64 v255, v[176:177], v[178:179] offset0:0 offset1:4
    s_waitcnt lgkmcnt(9)
    v_mfma_f32_16x16x32_bf16 v[192:195], v[240:243], v[128:131], v[192:195]
    v_mul_f32 v184, v13, v184
    v_mul_f32 v185, v13, v185
    v_mul_f32 v186, v13, v186
    v_mul_f32 v187, v13, v187
    v_cvt_pk_bf16_f32 v184, v184, v185
    v_mfma_f32_16x16x32_bf16 v[192:195], v[244:247], v[136:139], v[192:195]
    v_mul_f32 v188, v17, v188
    v_mul_f32 v189, v17, v189
    v_cvt_pk_bf16_f32 v185, v186, v187
    v_mul_f32 v190, v17, v190
    v_mfma_f32_16x16x32_bf16 v[196:199], v[232:235], v[100:103], v[196:199]
    ds_read_b64_tr_b16 v[232:233], v29 offset:57344
    ds_read_b64_tr_b16 v[234:235], v29 offset:61440
    v_mul_f32 v191, v17, v191
    v_cvt_pk_bf16_f32 v186, v188, v189
    v_cvt_pk_bf16_f32 v187, v190, v191
    v_mfma_f32_16x16x32_bf16 v[196:199], v[236:239], v[108:111], v[196:199]
    v_xor_b32 v255, 96, v6
    ds_write2st64_b64 v255, v[184:185], v[186:187] offset0:0 offset1:4
    ds_read_b128 v[160:163], v7 offset:0
    ds_read_b128 v[164:167], v7 offset:1024
    ds_read_b128 v[168:171], v7 offset:2048
    v_mfma_f32_16x16x32_bf16 v[196:199], v[240:243], v[132:135], v[196:199]
    ds_read_b64_tr_b16 v[236:237], v30 offset:32768
    ds_read_b64_tr_b16 v[238:239], v30 offset:36864
    ds_read_b128 v[172:175], v7 offset:3072
    v_mfma_f32_16x16x32_bf16 v[196:199], v[244:247], v[140:143], v[196:199]
    ds_read_b64_tr_b16 v[240:241], v30 offset:40960
    ds_read_b64_tr_b16 v[242:243], v30 offset:45056
    s_waitcnt lgkmcnt(14)
    v_mfma_f32_16x16x32_bf16 v[200:203], v[248:251], v[96:99], v[200:203]
    ds_read_b64_tr_b16 v[244:245], v30 offset:49152
    ds_read_b64_tr_b16 v[246:247], v30 offset:53248
    v_mfma_f32_16x16x32_bf16 v[200:203], v[224:227], v[104:107], v[200:203]
    s_waitcnt lgkmcnt(11)
    v_mfma_f32_16x16x32_bf16 v[200:203], v[228:231], v[128:131], v[200:203]
    v_mul_f32 v192, v13, v192
    v_mul_f32 v193, v13, v193
    v_mul_f32 v194, v13, v194
    v_mul_f32 v195, v13, v195
    v_cvt_pk_bf16_f32 v192, v192, v193
    v_mfma_f32_16x16x32_bf16 v[200:203], v[232:235], v[136:139], v[200:203]
    s_waitcnt lgkmcnt(9)
    buffer_store_dwordx4 v[160:163], v252, s[24:27], s29 offen offset:0 nt
    v_mul_f32 v196, v17, v196
    v_mul_f32 v197, v17, v197
    v_cvt_pk_bf16_f32 v193, v194, v195
    v_mfma_f32_16x16x32_bf16 v[204:207], v[248:251], v[100:103], v[204:207]
    ds_read_b64_tr_b16 v[248:249], v30 offset:57344
    ds_read_b64_tr_b16 v[250:251], v30 offset:61440
    s_waitcnt lgkmcnt(10)
    buffer_store_dwordx4 v[164:167], v252, s[24:27], s29 offen offset:2048 nt
    v_mul_f32 v198, v17, v198
    v_mul_f32 v199, v17, v199
    v_cvt_pk_bf16_f32 v194, v196, v197
    v_mfma_f32_16x16x32_bf16 v[204:207], v[224:227], v[108:111], v[204:207]
    s_waitcnt lgkmcnt(9)
    buffer_store_dwordx4 v[168:171], v252, s[24:27], s33 offen offset:0 nt
    v_cvt_pk_bf16_f32 v195, v198, v199
    ds_write2st64_b64 v6, v[192:193], v[194:195] offset0:0 offset1:4
    v_mfma_f32_16x16x32_bf16 v[204:207], v[228:231], v[132:135], v[204:207]
    ds_read_b64_tr_b16 v[224:225], v31 offset:32768
    ds_read_b64_tr_b16 v[226:227], v31 offset:36864
    v_mfma_f32_16x16x32_bf16 v[204:207], v[232:235], v[140:143], v[204:207]
    ds_read_b64_tr_b16 v[228:229], v31 offset:40960
    ds_read_b64_tr_b16 v[230:231], v31 offset:45056
    s_waitcnt lgkmcnt(9)
    v_mfma_f32_16x16x32_bf16 v[208:211], v[236:239], v[96:99], v[208:211]
    ds_read_b64_tr_b16 v[232:233], v31 offset:49152
    ds_read_b64_tr_b16 v[234:235], v31 offset:53248
    v_mfma_f32_16x16x32_bf16 v[208:211], v[240:243], v[104:107], v[208:211]
    s_waitcnt lgkmcnt(7)
    v_mfma_f32_16x16x32_bf16 v[208:211], v[244:247], v[128:131], v[208:211]
    v_mul_f32 v200, v13, v200
    buffer_store_dwordx4 v[172:175], v252, s[24:27], s33 offen offset:2048 nt
    v_mul_f32 v201, v13, v201
    v_mul_f32 v202, v13, v202
    v_mul_f32 v203, v13, v203
    v_mfma_f32_16x16x32_bf16 v[208:211], v[248:251], v[136:139], v[208:211]
    v_cvt_pk_bf16_f32 v200, v200, v201
    v_mul_f32 v204, v17, v204
    v_mul_f32 v205, v17, v205
    v_cvt_pk_bf16_f32 v201, v202, v203
    v_mfma_f32_16x16x32_bf16 v[212:215], v[236:239], v[100:103], v[212:215]
    ds_read_b64_tr_b16 v[236:237], v31 offset:57344
    ds_read_b64_tr_b16 v[238:239], v31 offset:61440
    v_mul_f32 v206, v17, v206
    v_mul_f32 v207, v17, v207
    v_cvt_pk_bf16_f32 v202, v204, v205
    v_cvt_pk_bf16_f32 v203, v206, v207
    v_mfma_f32_16x16x32_bf16 v[212:215], v[240:243], v[108:111], v[212:215]
    v_xor_b32 v255, 32, v6
    ds_write2st64_b64 v255, v[200:201], v[202:203] offset0:0 offset1:4
    v_mfma_f32_16x16x32_bf16 v[212:215], v[244:247], v[132:135], v[212:215]
    v_mfma_f32_16x16x32_bf16 v[212:215], v[248:251], v[140:143], v[212:215]
    s_waitcnt lgkmcnt(5)
    v_mfma_f32_16x16x32_bf16 v[216:219], v[224:227], v[96:99], v[216:219]
    v_mfma_f32_16x16x32_bf16 v[216:219], v[228:231], v[104:107], v[216:219]
    s_waitcnt lgkmcnt(1)
    v_mfma_f32_16x16x32_bf16 v[216:219], v[232:235], v[128:131], v[216:219]
    v_mul_f32 v208, v13, v208
    v_mul_f32 v209, v13, v209
    v_mul_f32 v210, v13, v210
    v_mul_f32 v211, v13, v211
    v_cvt_pk_bf16_f32 v208, v208, v209
    v_mfma_f32_16x16x32_bf16 v[216:219], v[236:239], v[136:139], v[216:219]
    v_mul_f32 v212, v17, v212
    v_mul_f32 v213, v17, v213
    v_cvt_pk_bf16_f32 v209, v210, v211
    v_mul_f32 v214, v17, v214
    v_mfma_f32_16x16x32_bf16 v[220:223], v[224:227], v[100:103], v[220:223]
    v_mul_f32 v215, v17, v215
    v_cvt_pk_bf16_f32 v210, v212, v213
    v_cvt_pk_bf16_f32 v211, v214, v215
    v_xor_b32 v255, 64, v6
    ds_write2st64_b64 v255, v[208:209], v[210:211] offset0:0 offset1:4
    v_mfma_f32_16x16x32_bf16 v[220:223], v[228:231], v[108:111], v[220:223]
    v_mfma_f32_16x16x32_bf16 v[220:223], v[232:235], v[132:135], v[220:223]
    v_mfma_f32_16x16x32_bf16 v[220:223], v[236:239], v[140:143], v[220:223]
    v_mul_f32 v216, v13, v216
    v_mul_f32 v217, v13, v217
    v_mul_f32 v218, v13, v218
    v_mul_f32 v219, v13, v219
    v_cvt_pk_bf16_f32 v216, v216, v217
    s_nop 2
    v_mul_f32 v220, v17, v220
    v_mul_f32 v221, v17, v221
    v_cvt_pk_bf16_f32 v217, v218, v219
    v_mul_f32 v222, v17, v222
    v_mul_f32 v223, v17, v223
    v_cvt_pk_bf16_f32 v218, v220, v221
    v_cvt_pk_bf16_f32 v219, v222, v223
    v_xor_b32 v255, 96, v6
    ds_write2st64_b64 v255, v[216:217], v[218:219] offset0:0 offset1:4
    ds_read_b128 v[192:195], v7 offset:0
    ds_read_b128 v[196:199], v7 offset:1024
    ds_read_b128 v[200:203], v7 offset:2048
    ds_read_b128 v[204:207], v7 offset:3072
    s_waitcnt lgkmcnt(3)
    buffer_store_dwordx4 v[192:195], v252, s[24:27], s29 offen offset:128 nt
    s_waitcnt lgkmcnt(2)
    buffer_store_dwordx4 v[196:199], v252, s[24:27], s29 offen offset:2176 nt
    s_waitcnt lgkmcnt(1)
    buffer_store_dwordx4 v[200:203], v252, s[24:27], s33 offen offset:128 nt
    s_waitcnt lgkmcnt(0)
    buffer_store_dwordx4 v[204:207], v252, s[24:27], s33 offen offset:2176 nt
    s_cmp_lg_u32 s34, 0
    s_cbranch_scc1 L_slow
L_end:
    s_endpgm
L_slow:
    s_waitcnt vmcnt(0) lgkmcnt(0)
    s_nop 15
    s_mov_b32 s46, s28
    s_mov_b32 s49, 1
    v_mbcnt_lo_u32_b32 v240, -1, 0
    v_mbcnt_hi_u32_b32 v240, -1, v240
    v_and_b32 v228, 15, v240
    v_lshlrev_b32 v228, 8, v228
    v_lshrrev_b32 v241, 4, v240
    v_lshl_add_u32 v228, v241, 4, v228
    v_lshlrev_b32 v229, 1, v241
    v_and_b32 v230, 15, v240
    v_xor_b32 v229, v229, v230
    v_lshlrev_b32 v229, 4, v229
    v_lshl_add_u32 v229, v241, 8, v229
    v_xor_b32 v230, 128, v229
    s_add_u32 s31, s35, 65536
    v_add_u32 v232, s31, v24
    v_add_u32 v233, s31, v25
    v_add_u32 v234, s31, v26
    v_add_u32 v235, s31, v27
    v_add_u32 v236, s31, v28
    v_add_u32 v237, s31, v29
    v_add_u32 v238, s31, v30
    v_add_u32 v239, s31, v31
L_shead:
    s_and_b32 s31, s34, s49
    s_cmp_eq_u32 s31, 0
    s_cbranch_scc1 L_snext
    s_add_u32 m0, s35, 131072
    s_add_u32 s31, s46, 0
    buffer_load_dwordx4 v1, s[12:15], s31 offen offset:0 nt lds
    s_add_u32 m0, s35, 132096
    s_add_u32 s31, s46, 2048
    buffer_load_dwordx4 v1, s[12:15], s31 offen offset:0 nt lds
    s_add_u32 m0, s35, 133120
    s_add_u32 s31, s46, 4096
    buffer_load_dwordx4 v1, s[12:15], s31 offen offset:0 nt lds
    s_add_u32 m0, s35, 134144
    s_add_u32 s31, s46, 6144
    buffer_load_dwordx4 v1, s[12:15], s31 offen offset:0 nt lds
    s_waitcnt vmcnt(0)
    v_xor_b32 v44, 64, v4
    ds_read_b128 v[32:35], v4 offset:32768
    ds_read_b128 v[36:39], v4 offset:34816
    ds_read_b128 v[40:43], v44 offset:32768
    ds_read_b128 v[44:47], v44 offset:34816
    s_waitcnt lgkmcnt(0)
    s_add_u32 m0, s35, 131072
    s_add_u32 s31, s46, 128
    buffer_load_dwordx4 v1, s[12:15], s31 offen offset:0 nt lds
    s_add_u32 m0, s35, 132096
    s_add_u32 s31, s46, 2176
    buffer_load_dwordx4 v1, s[12:15], s31 offen offset:0 nt lds
    s_add_u32 m0, s35, 133120
    s_add_u32 s31, s46, 4224
    buffer_load_dwordx4 v1, s[12:15], s31 offen offset:0 nt lds
    s_add_u32 m0, s35, 134144
    s_add_u32 s31, s46, 6272
    buffer_load_dwordx4 v1, s[12:15], s31 offen offset:0 nt lds
    s_waitcnt vmcnt(0)
    v_xor_b32 v60, 64, v4
    ds_read_b128 v[48:51], v4 offset:32768
    ds_read_b128 v[52:55], v4 offset:34816
    ds_read_b128 v[56:59], v60 offset:32768
    ds_read_b128 v[60:63], v60 offset:34816
    s_waitcnt lgkmcnt(0)
    v_mov_b32 v224, 0xff7fffff
    v_mov_b32 v225, 0xff7fffff
    v_mov_b32 v160, 0
    v_mov_b32 v161, 0
    v_mov_b32 v162, 0
    v_mov_b32 v163, 0
    v_mov_b32 v164, 0
    v_mov_b32 v165, 0
    v_mov_b32 v166, 0
    v_mov_b32 v167, 0
    v_mov_b32 v168, 0
    v_mov_b32 v169, 0
    v_mov_b32 v170, 0
    v_mov_b32 v171, 0
    v_mov_b32 v172, 0
    v_mov_b32 v173, 0
    v_mov_b32 v174, 0
    v_mov_b32 v175, 0
    v_mov_b32 v176, 0
    v_mov_b32 v177, 0
    v_mov_b32 v178, 0
    v_mov_b32 v179, 0
    v_mov_b32 v180, 0
    v_mov_b32 v181, 0
    v_mov_b32 v182, 0
    v_mov_b32 v183, 0
    v_mov_b32 v184, 0
    v_mov_b32 v185, 0
    v_mov_b32 v186, 0
    v_mov_b32 v187, 0
    v_mov_b32 v188, 0
    v_mov_b32 v189, 0
    v_mov_b32 v190, 0
    v_mov_b32 v191, 0
    v_mov_b32 v192, 0
    v_mov_b32 v193, 0
    v_mov_b32 v194, 0
    v_mov_b32 v195, 0
    v_mov_b32 v196, 0
    v_mov_b32 v197, 0
    v_mov_b32 v198, 0
    v_mov_b32 v199, 0
    v_mov_b32 v200, 0
    v_mov_b32 v201, 0
    v_mov_b32 v202, 0
    v_mov_b32 v203, 0
    v_mov_b32 v204, 0
    v_mov_b32 v205, 0
    v_mov_b32 v206, 0
    v_mov_b32 v207, 0
    v_mov_b32 v208, 0
    v_mov_b32 v209, 0
    v_mov_b32 v210, 0
    v_mov_b32 v211, 0
    v_mov_b32 v212, 0
    v_mov_b32 v213, 0
    v_mov_b32 v214, 0
    v_mov_b32 v215, 0
    v_mov_b32 v216, 0
    v_mov_b32 v217, 0
    v_mov_b32 v218, 0
    v_mov_b32 v219, 0
    v_mov_b32 v220, 0
    v_mov_b32 v221, 0
    v_mov_b32 v222, 0
    v_mov_b32 v223, 0
    v_mov_b32 v12, 0
    v_mov_b32 v13, 0
    v_mov_b32 v14, 0
    v_mov_b32 v15, 0
    v_mov_b32 v16, 0
    v_mov_b32 v17, 0
    v_mov_b32 v18, 0
    v_mov_b32 v19, 0
    s_mov_b32 s48, 0
    s_add_u32 s47, s46, 4096
    s_waitcnt vmcnt(0) lgkmcnt(0)
    s_nop 15
L_sloop:
    s_add_u32 s31, s46, s48
    s_add_u32 s36, s47, s48
    buffer_load_dwordx4 v[64:67], v228, s[16:19], s31 offen offset:0
    buffer_load_dwordx4 v[68:71], v228, s[16:19], s31 offen offset:64
    buffer_load_dwordx4 v[72:75], v228, s[16:19], s31 offen offset:128
    buffer_load_dwordx4 v[76:79], v228, s[16:19], s31 offen offset:192
    buffer_load_dwordx4 v[80:83], v228, s[16:19], s36 offen offset:0
    buffer_load_dwordx4 v[84:87], v228, s[16:19], s36 offen offset:64
    buffer_load_dwordx4 v[88:91], v228, s[16:19], s36 offen offset:128
    buffer_load_dwordx4 v[92:95], v228, s[16:19], s36 offen offset:192
    s_waitcnt vmcnt(7)
    v_mfma_f32_16x16x32_bf16 v[96:99], v[64:67], v[32:35], 0
    v_mfma_f32_16x16x32_bf16 v[104:107], v[64:67], v[36:39], 0
    s_waitcnt vmcnt(6)
    v_mfma_f32_16x16x32_bf16 v[96:99], v[68:71], v[40:43], v[96:99]
    v_mfma_f32_16x16x32_bf16 v[104:107], v[68:71], v[44:47], v[104:107]
    s_waitcnt vmcnt(5)
    v_mfma_f32_16x16x32_bf16 v[96:99], v[72:75], v[48:51], v[96:99]
    v_mfma_f32_16x16x32_bf16 v[104:107], v[72:75], v[52:55], v[104:107]
    s_waitcnt vmcnt(4)
    v_mfma_f32_16x16x32_bf16 v[96:99], v[76:79], v[56:59], v[96:99]
    v_mfma_f32_16x16x32_bf16 v[104:107], v[76:79], v[60:63], v[104:107]
    s_waitcnt vmcnt(3)
    v_mfma_f32_16x16x32_bf16 v[100:103], v[80:83], v[32:35], 0
    v_mfma_f32_16x16x32_bf16 v[108:111], v[80:83], v[36:39], 0
    s_waitcnt vmcnt(2)
    v_mfma_f32_16x16x32_bf16 v[100:103], v[84:87], v[40:43], v[100:103]
    v_mfma_f32_16x16x32_bf16 v[108:111], v[84:87], v[44:47], v[108:111]
    s_waitcnt vmcnt(1)
    v_mfma_f32_16x16x32_bf16 v[100:103], v[88:91], v[48:51], v[100:103]
    v_mfma_f32_16x16x32_bf16 v[108:111], v[88:91], v[52:55], v[108:111]
    s_waitcnt vmcnt(0)
    v_mfma_f32_16x16x32_bf16 v[100:103], v[92:95], v[56:59], v[100:103]
    v_mfma_f32_16x16x32_bf16 v[108:111], v[92:95], v[60:63], v[108:111]
    v_max3_f32 v0, v224, v96, v97
    v_max3_f32 v0, v0, v98, v99
    s_nop 4
    v_max3_f32 v0, v0, v100, v101
    v_max3_f32 v0, v0, v102, v103
    v_max3_f32 v5, v225, v104, v105
    v_max3_f32 v5, v5, v106, v107
    v_max3_f32 v5, v5, v108, v109
    v_max3_f32 v5, v5, v110, v111
    s_nop 1
    v_permlane32_swap_b32 v0, v5
    v_max_f32 v0, v0, v5
    v_mov_b32 v5, v0
    s_nop 1
    v_permlane16_swap_b32 v0, v5
    v_max_f32 v0, v0, v5
    v_mov_b32 v5, v0
    s_nop 1
    v_permlane32_swap_b32 v0, v5
    v_sub_f32 v226, v224, v0
    v_mul_f32 v226, s40, v226
    v_exp_f32 v226, v226
    v_mov_b32 v224, v0
    v_mul_f32 v253, s41, v0
    v_sub_f32 v227, v225, v5
    v_mul_f32 v227, s40, v227
    v_exp_f32 v227, v227
    v_mov_b32 v225, v5
    v_mul_f32 v254, s41, v5
    v_fmamk_f32 v96, v96, 0x3e0293ee, v253
    v_fmamk_f32 v97, v97, 0x3e0293ee, v253
    v_fmamk_f32 v98, v98, 0x3e0293ee, v253
    v_fmamk_f32 v99, v99, 0x3e0293ee, v253
    v_fmamk_f32 v100, v100, 0x3e0293ee, v253
    v_fmamk_f32 v101, v101, 0x3e0293ee, v253
    v_fmamk_f32 v102, v102, 0x3e0293ee, v253
    v_fmamk_f32 v103, v103, 0x3e0293ee, v253
    v_fmamk_f32 v104, v104, 0x3e0293ee, v254
    v_fmamk_f32 v105, v105, 0x3e0293ee, v254
    v_fmamk_f32 v106, v106, 0x3e0293ee, v254
    v_fmamk_f32 v107, v107, 0x3e0293ee, v254
    v_fmamk_f32 v108, v108, 0x3e0293ee, v254
    v_fmamk_f32 v109, v109, 0x3e0293ee, v254
    v_fmamk_f32 v110, v110, 0x3e0293ee, v254
    v_fmamk_f32 v111, v111, 0x3e0293ee, v254
    v_exp_f32 v96, v96
    v_exp_f32 v97, v97
    v_exp_f32 v98, v98
    v_exp_f32 v99, v99
    v_exp_f32 v100, v100
    v_exp_f32 v101, v101
    v_exp_f32 v102, v102
    v_exp_f32 v103, v103
    v_exp_f32 v104, v104
    v_exp_f32 v105, v105
    v_exp_f32 v106, v106
    v_exp_f32 v107, v107
    v_exp_f32 v108, v108
    v_exp_f32 v109, v109
    v_exp_f32 v110, v110
    v_exp_f32 v111, v111
    v_mul_f32 v160, v226, v160
    v_mul_f32 v161, v226, v161
    v_mul_f32 v162, v226, v162
    v_mul_f32 v163, v226, v163
    v_mul_f32 v164, v227, v164
    v_mul_f32 v165, v227, v165
    v_mul_f32 v166, v227, v166
    v_mul_f32 v167, v227, v167
    v_mul_f32 v168, v226, v168
    v_mul_f32 v169, v226, v169
    v_mul_f32 v170, v226, v170
    v_mul_f32 v171, v226, v171
    v_mul_f32 v172, v227, v172
    v_mul_f32 v173, v227, v173
    v_mul_f32 v174, v227, v174
    v_mul_f32 v175, v227, v175
    v_mul_f32 v176, v226, v176
    v_mul_f32 v177, v226, v177
    v_mul_f32 v178, v226, v178
    v_mul_f32 v179, v226, v179
    v_mul_f32 v180, v227, v180
    v_mul_f32 v181, v227, v181
    v_mul_f32 v182, v227, v182
    v_mul_f32 v183, v227, v183
    v_mul_f32 v184, v226, v184
    v_mul_f32 v185, v226, v185
    v_mul_f32 v186, v226, v186
    v_mul_f32 v187, v226, v187
    v_mul_f32 v188, v227, v188
    v_mul_f32 v189, v227, v189
    v_mul_f32 v190, v227, v190
    v_mul_f32 v191, v227, v191
    v_mul_f32 v192, v226, v192
    v_mul_f32 v193, v226, v193
    v_mul_f32 v194, v226, v194
    v_mul_f32 v195, v226, v195
    v_mul_f32 v196, v227, v196
    v_mul_f32 v197, v227, v197
    v_mul_f32 v198, v227, v198
    v_mul_f32 v199, v227, v199
    v_mul_f32 v200, v226, v200
    v_mul_f32 v201, v226, v201
    v_mul_f32 v202, v226, v202
    v_mul_f32 v203, v226, v203
    v_mul_f32 v204, v227, v204
    v_mul_f32 v205, v227, v205
    v_mul_f32 v206, v227, v206
    v_mul_f32 v207, v227, v207
    v_mul_f32 v208, v226, v208
    v_mul_f32 v209, v226, v209
    v_mul_f32 v210, v226, v210
    v_mul_f32 v211, v226, v211
    v_mul_f32 v212, v227, v212
    v_mul_f32 v213, v227, v213
    v_mul_f32 v214, v227, v214
    v_mul_f32 v215, v227, v215
    v_mul_f32 v216, v226, v216
    v_mul_f32 v217, v226, v217
    v_mul_f32 v218, v226, v218
    v_mul_f32 v219, v226, v219
    v_mul_f32 v220, v227, v220
    v_mul_f32 v221, v227, v221
    v_mul_f32 v222, v227, v222
    v_mul_f32 v223, v227, v223
    v_mul_f32 v12, v226, v12
    v_mul_f32 v16, v227, v16
    v_cvt_pk_bf16_f32 v96, v96, v97
    v_cvt_pk_bf16_f32 v97, v98, v99
    v_cvt_pk_bf16_f32 v98, v100, v101
    v_cvt_pk_bf16_f32 v99, v102, v103
    v_cvt_pk_bf16_f32 v100, v104, v105
    v_cvt_pk_bf16_f32 v101, v106, v107
    v_cvt_pk_bf16_f32 v102, v108, v109
    v_cvt_pk_bf16_f32 v103, v110, v111
    s_add_u32 m0, s35, 131072
    s_nop 0
    buffer_load_dwordx4 v229, s[20:23], s31 offen offset:0 lds
    buffer_load_dwordx4 v230, s[20:23], s31 offen offset:1024 lds
    buffer_load_dwordx4 v229, s[20:23], s31 offen offset:2048 lds
    buffer_load_dwordx4 v230, s[20:23], s31 offen offset:3072 lds
    s_waitcnt vmcnt(0)
    ds_read_b64_tr_b16 v[64:65], v232 offset:0
    ds_read_b64_tr_b16 v[68:69], v233 offset:0
    ds_read_b64_tr_b16 v[72:73], v234 offset:0
    ds_read_b64_tr_b16 v[76:77], v235 offset:0
    ds_read_b64_tr_b16 v[80:81], v236 offset:0
    ds_read_b64_tr_b16 v[84:85], v237 offset:0
    ds_read_b64_tr_b16 v[88:89], v238 offset:0
    ds_read_b64_tr_b16 v[92:93], v239 offset:0
    s_waitcnt lgkmcnt(0)
    s_add_u32 m0, s35, 131072
    s_nop 0
    buffer_load_dwordx4 v229, s[20:23], s36 offen offset:0 lds
    buffer_load_dwordx4 v230, s[20:23], s36 offen offset:1024 lds
    buffer_load_dwordx4 v229, s[20:23], s36 offen offset:2048 lds
    buffer_load_dwordx4 v230, s[20:23], s36 offen offset:3072 lds
    s_waitcnt vmcnt(0)
    ds_read_b64_tr_b16 v[66:67], v232 offset:0
    ds_read_b64_tr_b16 v[70:71], v233 offset:0
    ds_read_b64_tr_b16 v[74:75], v234 offset:0
    ds_read_b64_tr_b16 v[78:79], v235 offset:0
    ds_read_b64_tr_b16 v[82:83], v236 offset:0
    ds_read_b64_tr_b16 v[86:87], v237 offset:0
    ds_read_b64_tr_b16 v[90:91], v238 offset:0
    ds_read_b64_tr_b16 v[94:95], v239 offset:0
    s_waitcnt lgkmcnt(0)
    v_mfma_f32_16x16x32_bf16 v[160:163], v[64:67], v[96:99], v[160:163]
    v_mfma_f32_16x16x32_bf16 v[164:167], v[64:67], v[100:103], v[164:167]
    v_mfma_f32_16x16x32_bf16 v[168:171], v[68:71], v[96:99], v[168:171]
    v_mfma_f32_16x16x32_bf16 v[172:175], v[68:71], v[100:103], v[172:175]
    v_mfma_f32_16x16x32_bf16 v[176:179], v[72:75], v[96:99], v[176:179]
    v_mfma_f32_16x16x32_bf16 v[180:183], v[72:75], v[100:103], v[180:183]
    v_mfma_f32_16x16x32_bf16 v[184:187], v[76:79], v[96:99], v[184:187]
    v_mfma_f32_16x16x32_bf16 v[188:191], v[76:79], v[100:103], v[188:191]
    v_mfma_f32_16x16x32_bf16 v[192:195], v[80:83], v[96:99], v[192:195]
    v_mfma_f32_16x16x32_bf16 v[196:199], v[80:83], v[100:103], v[196:199]
    v_mfma_f32_16x16x32_bf16 v[200:203], v[84:87], v[96:99], v[200:203]
    v_mfma_f32_16x16x32_bf16 v[204:207], v[84:87], v[100:103], v[204:207]
    v_mfma_f32_16x16x32_bf16 v[208:211], v[88:91], v[96:99], v[208:211]
    v_mfma_f32_16x16x32_bf16 v[212:215], v[88:91], v[100:103], v[212:215]
    v_mfma_f32_16x16x32_bf16 v[216:219], v[92:95], v[96:99], v[216:219]
    v_mfma_f32_16x16x32_bf16 v[220:223], v[92:95], v[100:103], v[220:223]
    v_mfma_f32_16x16x32_bf16 v[12:15], v[8:11], v[96:99], v[12:15]
    v_mfma_f32_16x16x32_bf16 v[16:19], v[8:11], v[100:103], v[16:19]
    s_waitcnt vmcnt(0) lgkmcnt(0)
    s_nop 15
    s_add_u32 s48, s48, 8192
    s_cmp_lt_u32 s48, 65536
    s_cbranch_scc1 L_sloop
    v_rcp_f32 v13, v12
    v_rcp_f32 v17, v16
    v_mul_f32 v160, v13, v160
    v_mul_f32 v161, v13, v161
    v_mul_f32 v162, v13, v162
    v_mul_f32 v163, v13, v163
    v_cvt_pk_bf16_f32 v160, v160, v161
    v_mul_f32 v164, v17, v164
    v_mul_f32 v165, v17, v165
    v_cvt_pk_bf16_f32 v161, v162, v163
    v_mul_f32 v166, v17, v166
    v_mul_f32 v167, v17, v167
    v_cvt_pk_bf16_f32 v162, v164, v165
    v_cvt_pk_bf16_f32 v163, v166, v167
    ds_write2st64_b64 v6, v[160:161], v[162:163] offset0:0 offset1:4
    v_mul_f32 v168, v13, v168
    v_mul_f32 v169, v13, v169
    v_mul_f32 v170, v13, v170
    v_mul_f32 v171, v13, v171
    v_cvt_pk_bf16_f32 v168, v168, v169
    v_mul_f32 v172, v17, v172
    v_mul_f32 v173, v17, v173
    v_cvt_pk_bf16_f32 v169, v170, v171
    v_mul_f32 v174, v17, v174
    v_mul_f32 v175, v17, v175
    v_cvt_pk_bf16_f32 v170, v172, v173
    v_cvt_pk_bf16_f32 v171, v174, v175
    v_xor_b32 v255, 32, v6
    ds_write2st64_b64 v255, v[168:169], v[170:171] offset0:0 offset1:4
    v_mul_f32 v176, v13, v176
    v_mul_f32 v177, v13, v177
    v_mul_f32 v178, v13, v178
    v_mul_f32 v179, v13, v179
    v_cvt_pk_bf16_f32 v176, v176, v177
    v_mul_f32 v180, v17, v180
    v_mul_f32 v181, v17, v181
    v_cvt_pk_bf16_f32 v177, v178, v179
    v_mul_f32 v182, v17, v182
    v_mul_f32 v183, v17, v183
    v_cvt_pk_bf16_f32 v178, v180, v181
    v_cvt_pk_bf16_f32 v179, v182, v183
    v_xor_b32 v255, 64, v6
    ds_write2st64_b64 v255, v[176:177], v[178:179] offset0:0 offset1:4
    v_mul_f32 v184, v13, v184
    v_mul_f32 v185, v13, v185
    v_mul_f32 v186, v13, v186
    v_mul_f32 v187, v13, v187
    v_cvt_pk_bf16_f32 v184, v184, v185
    v_mul_f32 v188, v17, v188
    v_mul_f32 v189, v17, v189
    v_cvt_pk_bf16_f32 v185, v186, v187
    v_mul_f32 v190, v17, v190
    v_mul_f32 v191, v17, v191
    v_cvt_pk_bf16_f32 v186, v188, v189
    v_cvt_pk_bf16_f32 v187, v190, v191
    v_xor_b32 v255, 96, v6
    ds_write2st64_b64 v255, v[184:185], v[186:187] offset0:0 offset1:4
    ds_read_b128 v[160:163], v7 offset:0
    ds_read_b128 v[164:167], v7 offset:1024
    ds_read_b128 v[168:171], v7 offset:2048
    ds_read_b128 v[172:175], v7 offset:3072
    s_waitcnt lgkmcnt(3)
    buffer_store_dwordx4 v[160:163], v252, s[24:27], s46 offen offset:0 nt
    s_waitcnt lgkmcnt(2)
    buffer_store_dwordx4 v[164:167], v252, s[24:27], s46 offen offset:2048 nt
    s_waitcnt lgkmcnt(1)
    buffer_store_dwordx4 v[168:171], v252, s[24:27], s47 offen offset:0 nt
    s_waitcnt lgkmcnt(0)
    buffer_store_dwordx4 v[172:175], v252, s[24:27], s47 offen offset:2048 nt
    v_mul_f32 v192, v13, v192
    v_mul_f32 v193, v13, v193
    v_mul_f32 v194, v13, v194
    v_mul_f32 v195, v13, v195
    v_cvt_pk_bf16_f32 v192, v192, v193
    v_mul_f32 v196, v17, v196
    v_mul_f32 v197, v17, v197
    v_cvt_pk_bf16_f32 v193, v194, v195
    v_mul_f32 v198, v17, v198
    v_mul_f32 v199, v17, v199
    v_cvt_pk_bf16_f32 v194, v196, v197
    v_cvt_pk_bf16_f32 v195, v198, v199
    ds_write2st64_b64 v6, v[192:193], v[194:195] offset0:0 offset1:4
    v_mul_f32 v200, v13, v200
    v_mul_f32 v201, v13, v201
    v_mul_f32 v202, v13, v202
    v_mul_f32 v203, v13, v203
    v_cvt_pk_bf16_f32 v200, v200, v201
    v_mul_f32 v204, v17, v204
    v_mul_f32 v205, v17, v205
    v_cvt_pk_bf16_f32 v201, v202, v203
    v_mul_f32 v206, v17, v206
    v_mul_f32 v207, v17, v207
    v_cvt_pk_bf16_f32 v202, v204, v205
    v_cvt_pk_bf16_f32 v203, v206, v207
    v_xor_b32 v255, 32, v6
    ds_write2st64_b64 v255, v[200:201], v[202:203] offset0:0 offset1:4
    v_mul_f32 v208, v13, v208
    v_mul_f32 v209, v13, v209
    v_mul_f32 v210, v13, v210
    v_mul_f32 v211, v13, v211
    v_cvt_pk_bf16_f32 v208, v208, v209
    v_mul_f32 v212, v17, v212
    v_mul_f32 v213, v17, v213
    v_cvt_pk_bf16_f32 v209, v210, v211
    v_mul_f32 v214, v17, v214
    v_mul_f32 v215, v17, v215
    v_cvt_pk_bf16_f32 v210, v212, v213
    v_cvt_pk_bf16_f32 v211, v214, v215
    v_xor_b32 v255, 64, v6
    ds_write2st64_b64 v255, v[208:209], v[210:211] offset0:0 offset1:4
    v_mul_f32 v216, v13, v216
    v_mul_f32 v217, v13, v217
    v_mul_f32 v218, v13, v218
    v_mul_f32 v219, v13, v219
    v_cvt_pk_bf16_f32 v216, v216, v217
    v_mul_f32 v220, v17, v220
    v_mul_f32 v221, v17, v221
    v_cvt_pk_bf16_f32 v217, v218, v219
    v_mul_f32 v222, v17, v222
    v_mul_f32 v223, v17, v223
    v_cvt_pk_bf16_f32 v218, v220, v221
    v_cvt_pk_bf16_f32 v219, v222, v223
    v_xor_b32 v255, 96, v6
    ds_write2st64_b64 v255, v[216:217], v[218:219] offset0:0 offset1:4
    ds_read_b128 v[192:195], v7 offset:0
    ds_read_b128 v[196:199], v7 offset:1024
    ds_read_b128 v[200:203], v7 offset:2048
    ds_read_b128 v[204:207], v7 offset:3072
    s_waitcnt lgkmcnt(3)
    buffer_store_dwordx4 v[192:195], v252, s[24:27], s46 offen offset:128 nt
    s_waitcnt lgkmcnt(2)
    buffer_store_dwordx4 v[196:199], v252, s[24:27], s46 offen offset:2176 nt
    s_waitcnt lgkmcnt(1)
    buffer_store_dwordx4 v[200:203], v252, s[24:27], s47 offen offset:128 nt
    s_waitcnt lgkmcnt(0)
    buffer_store_dwordx4 v[204:207], v252, s[24:27], s47 offen offset:2176 nt
    s_waitcnt vmcnt(0) lgkmcnt(0)
    s_nop 15
L_snext:
    s_mov_b32 s46, s29
    s_lshl_b32 s49, s49, 1
    s_cmp_le_u32 s49, 2
    s_cbranch_scc1 L_shead
    s_endpgm
.section .rodata,"a"
.p2align 6
.amdhsa_kernel standalone__mha_softmax__near_ridge_kernel
  .amdhsa_next_free_vgpr 256
  .amdhsa_next_free_sgpr 102
  .amdhsa_accum_offset 256
  .amdhsa_group_segment_fixed_size 0
  .amdhsa_kernarg_size 48
  .amdhsa_user_sgpr_count 2
  .amdhsa_user_sgpr_kernarg_segment_ptr 1
  .amdhsa_system_sgpr_workgroup_id_x 1
.end_amdhsa_kernel
```
